```python
import torch

def _softmax(x, axis=-1):
    return torch.softmax(x, dim=axis)
def _gelu(x):
    return torch.nn.functional.gelu(x, approximate="tanh")
def _silu(x):
    return torch.nn.functional.silu(x)
def _sigmoid(x):
    return torch.sigmoid(x)
def _layernorm(x, axis=-1, eps=1e-5):
    m = x.mean(dim=axis, keepdim=True)
    v = x.var(dim=axis, keepdim=True, unbiased=False)
    return (x - m) / torch.sqrt(v + eps)
def _scatter_add(tgt, idx, src, axis=0):
    return tgt.clone().index_add_(axis, idx, src)
def _segment_sum(src, seg, n):
    out = torch.zeros((n,) + src.shape[1:], dtype=src.dtype)
    return out.index_add_(0, seg, src)
def _pad(x, pw):
    flat = tuple(v for pair in reversed(pw) for v in pair)
    return torch.nn.functional.pad(x, flat)

kernel_name = 'gated_mix__ssm_conv_s5__ssm_conv_s5__prompt'

def setup_inputs():

    _w = (lambda a: (lambda t: t.to(torch.bfloat16) if t.is_floating_point() else t)(torch.as_tensor(a)))
    def _A_setup():
        B, S, D = 1, 2048, 640
        P = D
        Lambda_re = -0.5 * (lambda _x: torch.exp(torch.as_tensor(_x)))((lambda *s: torch.randn(*s, dtype=torch.bfloat16) * 0.2)(P))
        Lambda_im = (lambda *s: torch.randn(*s, dtype=torch.bfloat16) * 0.4)(P) * 1.0
        B_re = (lambda *s: torch.randn(*s, dtype=torch.bfloat16) * 0.2)(P, D) * (D ** -0.5)
        B_im = (lambda *s: torch.randn(*s, dtype=torch.bfloat16) * 0.2)(P, D) * (D ** -0.5)
        C_re = (lambda *s: torch.randn(*s, dtype=torch.bfloat16) * 0.2)(D, P) * (P ** -0.5)
        C_im = (lambda *s: torch.randn(*s, dtype=torch.bfloat16) * 0.2)(D, P) * (P ** -0.5)
        log_dt = (lambda *s: torch.randn(*s, dtype=torch.bfloat16) * 0.2)(P) * 0.3 - 2.0
        Dskip = (lambda *s: torch.randn(*s, dtype=torch.bfloat16) * 0.05)(D)
        return {
            "x": _w((lambda *s: torch.randn(*s, dtype=torch.bfloat16) * 0.05)(B, S, D)),
            "Lambda_re": _w(Lambda_re),
            "Lambda_im": _w(Lambda_im),
            "B_re": _w(B_re),
            "B_im": _w(B_im),
            "C_re": _w(C_re),
            "C_im": _w(C_im),
            "log_dt": _w(log_dt),
            "Dskip": _w(Dskip),
        }
    _A_in = _A_setup()

    def _B_setup():
        B, S, D = 1, 2048, 640
        P = D
        Lambda_re = -0.5 * (lambda _x: torch.exp(torch.as_tensor(_x)))((lambda *s: torch.randn(*s, dtype=torch.bfloat16) * 0.2)(P))
        Lambda_im = (lambda *s: torch.randn(*s, dtype=torch.bfloat16) * 0.4)(P) * 1.0
        B_re = (lambda *s: torch.randn(*s, dtype=torch.bfloat16) * 0.2)(P, D) * (D ** -0.5)
        B_im = (lambda *s: torch.randn(*s, dtype=torch.bfloat16) * 0.2)(P, D) * (D ** -0.5)
        C_re = (lambda *s: torch.randn(*s, dtype=torch.bfloat16) * 0.2)(D, P) * (P ** -0.5)
        C_im = (lambda *s: torch.randn(*s, dtype=torch.bfloat16) * 0.2)(D, P) * (P ** -0.5)
        log_dt = (lambda *s: torch.randn(*s, dtype=torch.bfloat16) * 0.2)(P) * 0.3 - 2.0
        Dskip = (lambda *s: torch.randn(*s, dtype=torch.bfloat16) * 0.05)(D)
        return {
            "x": _w((lambda *s: torch.randn(*s, dtype=torch.bfloat16) * 0.05)(B, S, D)),
            "Lambda_re": _w(Lambda_re),
            "Lambda_im": _w(Lambda_im),
            "B_re": _w(B_re),
            "B_im": _w(B_im),
            "C_re": _w(C_re),
            "C_im": _w(C_im),
            "log_dt": _w(log_dt),
            "Dskip": _w(Dskip),
        }
    _B_in = _B_setup()

    return {
        "A_x": _A_in["x"],
        "A_Lambda_re": _A_in["Lambda_re"],
        "A_Lambda_im": _A_in["Lambda_im"],
        "A_B_re": _A_in["B_re"],
        "A_B_im": _A_in["B_im"],
        "A_C_re": _A_in["C_re"],
        "A_C_im": _A_in["C_im"],
        "A_log_dt": _A_in["log_dt"],
        "A_Dskip": _A_in["Dskip"],
        "B_x": _B_in["x"],
        "B_Lambda_re": _B_in["Lambda_re"],
        "B_Lambda_im": _B_in["Lambda_im"],
        "B_B_re": _B_in["B_re"],
        "B_B_im": _B_in["B_im"],
        "B_C_re": _B_in["C_re"],
        "B_C_im": _B_in["C_im"],
        "B_log_dt": _B_in["log_dt"],
        "B_Dskip": _B_in["Dskip"],
        "gate_w": _w((lambda *s: torch.randn(*s, dtype=torch.bfloat16) * 0.05)(640) * 16.0),
    }

def reference(A_x, A_Lambda_re, A_Lambda_im, A_B_re, A_B_im, A_C_re, A_C_im, A_log_dt, A_Dskip, B_x, B_Lambda_re, B_Lambda_im, B_B_re, B_B_im, B_C_re, B_C_im, B_log_dt, B_Dskip, gate_w):
    def _A_ref(x, Lambda_re, Lambda_im, B_re, B_im, C_re, C_im, log_dt, Dskip):
        Bsz, L, H = x.shape
        Lam = Lambda_re + 1j * Lambda_im
        Bmat = B_re + 1j * B_im
        Cmat = C_re + 1j * C_im
        dt = torch.exp(log_dt)
        Lam_bar = torch.exp(dt * Lam)
        B_bar = ((Lam_bar - 1.0) / Lam)[:, None] * Bmat
        Bu = torch.einsum("bld,pd->blp", x + 0j, B_bar)
        h = torch.zeros_like(Bu[:, 0, :])
        hs = []
        for t in range(L):
            h = Lam_bar[None, :] * h + Bu[:, t, :]
            hs.append(h)
        hseq = torch.stack(hs, 1)
        y = 2.0 * torch.einsum("blp,dp->bld", hseq, Cmat).real + x * Dskip[None, None, :]
        return y

    def _B_ref(x, Lambda_re, Lambda_im, B_re, B_im, C_re, C_im, log_dt, Dskip):
        Bsz, L, H = x.shape
        Lam = Lambda_re + 1j * Lambda_im
        Bmat = B_re + 1j * B_im
        Cmat = C_re + 1j * C_im
        dt = torch.exp(log_dt)
        Lam_bar = torch.exp(dt * Lam)
        B_bar = ((Lam_bar - 1.0) / Lam)[:, None] * Bmat
        Bu = torch.einsum("bld,pd->blp", x + 0j, B_bar)
        h = torch.zeros_like(Bu[:, 0, :])
        hs = []
        for t in range(L):
            h = Lam_bar[None, :] * h + Bu[:, t, :]
            hs.append(h)
        hseq = torch.stack(hs, 1)
        y = 2.0 * torch.einsum("blp,dp->bld", hseq, Cmat).real + x * Dskip[None, None, :]
        return y

    x = A_x
    g = _sigmoid((x * gate_w).sum(-1, keepdims=True))
    a = _A_ref(x, A_Lambda_re, A_Lambda_im, A_B_re, A_B_im, A_C_re, A_C_im, A_log_dt, A_Dskip)
    b = _B_ref(x, B_Lambda_re, B_Lambda_im, B_B_re, B_B_im, B_C_re, B_C_im, B_log_dt, B_Dskip)
    return g * a + (1 - g) * b
```

```asm
; @launch grid=(256,1,1) block=(256,1,1) lds=163840
.amdgcn_target "amdgcn-amd-amdhsa--gfx950"
.text
.globl gated_mix__ssm_conv_s5__ssm_conv_s5__prompt_kernel
.p2align 8
.type gated_mix__ssm_conv_s5__ssm_conv_s5__prompt_kernel,@function
gated_mix__ssm_conv_s5__ssm_conv_s5__prompt_kernel:
s_cmp_ge_u32 s2, 256
s_cbranch_scc1 L_end
s_load_dwordx16 s[44:59], s[0:1], 0
s_load_dwordx16 s[60:75], s[0:1], 64
s_load_dwordx8 s[76:83], s[0:1], 128
s_load_dwordx4 s[84:87], s[0:1], 160
s_getpc_b64 s[98:99]
L_pc:
s_lshr_b32 s96, s2, 3
v_min_u32 v2, 7, v0
v_lshl_add_u32 v2, s96, 3, v2
v_lshlrev_b32 v2, 7, v2
v_min_u32 v2, L_last-L_pc, v2
global_load_dword v255, v2, s[98:99]
v_lshrrev_b32 v4, 6, v0
v_and_b32 v1, 63, v0
v_readfirstlane_b32 s3, v4
s_and_b32 s101, s2, 7
s_and_b32 s88, s101, 1
s_lshl_b32 s88, s88, 3
s_and_b32 s91, s96, 7
s_add_u32 s88, s88, s91
s_lshr_b32 s89, s101, 1
s_lshl_b32 s89, s89, 2
s_lshr_b32 s95, s96, 3
s_add_u32 s89, s89, s95
s_mul_i32 s95, s88, 1
s_mul_i32 s97, s89, 3
s_add_u32 s95, s95, s97
s_mul_i32 s97, s95, 6554
s_lshr_b32 s97, s97, 16
s_mul_i32 s97, s97, 10
s_sub_u32 s95, s95, s97
s_lshl_b32 s95, s95, 7
s_lshl_b32 s92, s3, 12
s_mul_i32 s93, s3, 5120
s_add_u32 s93, s93, 16384
s_mul_i32 s94, s3, 10240
v_lshrrev_b32 v4, 4, v1
v_and_b32 v5, 7, v1
v_xor_b32 v5, v5, v4
v_lshlrev_b32 v5, 4, v5
v_lshrrev_b32 v6, 5, v1
v_lshlrev_b32 v6, 3, v6
v_bfe_u32 v8, v1, 3, 1
v_lshl_add_u32 v6, v8, 2, v6
v_and_b32 v8, 1, v4
v_add_u32 v6, v6, v8
s_lshl_b32 s97, s88, 7
s_lshl_b32 s98, s3, 5
s_add_u32 s97, s97, s98
v_add_u32 v6, s97, v6
v_mul_u32_u24 v6, 1280, v6
v_add_u32 v172, v6, v5
v_xor_b32 v6, 64, v172
v_add_u32 v173, 19456, v6
v_add_u32 v174, 512, v172
v_add_u32 v175, 19968, v6
v_lshrrev_b32 v7, 3, v1
v_mul_u32_u24 v7, 1280, v7
v_add_u32 v7, v7, v5
s_and_b32 s97, s89, 7
s_mul_i32 s97, s97, 80
s_and_b32 s98, s3, 1
s_mul_i32 s99, s98, 40
s_add_u32 s99, s99, s97
s_mul_i32 s99, s99, 1280
s_lshl_b32 s98, s98, 6
v_xor_b32 v8, s98, v7
v_add_u32 v248, s99, v8
v_xor_b32 v8, 64, v248
v_add_u32 v249, 9216, v8
v_add_u32 v250, 18432, v248
v_add_u32 v251, 27648, v8
v_add_u32 v252, 40960, v248
s_mul_i32 s98, s3, 20
v_add_u32 v10, s98, v1
v_add_u32 v9, s97, v10
v_lshlrev_b32 v9, 1, v9
s_waitcnt lgkmcnt(0)
s_mov_b32 s4, s44
s_mov_b32 s5, s45
s_mov_b32 s6, 2621440
s_mov_b32 s7, 0x20000
s_cmp_ge_u32 s89, 8
s_cselect_b64 s[50:51], s[68:69], s[50:51]
s_cselect_b64 s[52:53], s[70:71], s[52:53]
s_cselect_b64 s[32:33], s[64:65], s[46:47]
s_cselect_b64 s[36:37], s[66:67], s[48:49]
s_cselect_b64 s[40:41], s[76:77], s[58:59]
s_cmp_ge_u32 s3, 2
s_cselect_b64 s[8:9], s[52:53], s[50:51]
s_mov_b32 s10, 819200
s_mov_b32 s11, 0x20000
s_mov_b32 s34, 1280
s_mov_b32 s35, 0x20000
s_mov_b32 s38, 1280
s_mov_b32 s39, 0x20000
s_mov_b32 s42, 1280
s_mov_b32 s43, 0x20000
buffer_load_ushort v11, v9, s[32:35], 0 offen
buffer_load_ushort v12, v9, s[36:39], 0 offen
buffer_load_ushort v13, v9, s[40:43], 0 offen
s_add_u32 m0, s92, 0
s_nop 0
buffer_load_dwordx4 v172, s[4:7], s95 offen offset:0  lds
buffer_load_dwordx4 v173, s[4:7], s95 offen offset:1024  lds
buffer_load_dwordx4 v174, s[4:7], s95 offen offset:2048  lds
buffer_load_dwordx4 v175, s[4:7], s95 offen offset:3072  lds
s_add_u32 m0, s93, 0
s_nop 0
buffer_load_dwordx4 v248, s[8:11], s95 offen offset:0  lds
buffer_load_dwordx4 v249, s[8:11], s95 offen offset:1024  lds
buffer_load_dwordx4 v250, s[8:11], s95 offen offset:2048  lds
buffer_load_dwordx4 v251, s[8:11], s95 offen offset:3072  lds
s_add_u32 m0, s93, 4096
s_nop 0
buffer_load_dwordx4 v252, s[8:11], s95 offen offset:0  lds
s_add_u32 s95, s95, 128
s_cmp_eq_u32 s95, 1280
s_cselect_b32 s95, 0, s95
s_bitcmp1_b32 s2, 0
s_cselect_b64 s[54:55], s[72:73], s[54:55]
s_cselect_b64 s[56:57], s[74:75], s[56:57]
s_cselect_b64 s[36:37], s[78:79], s[60:61]
s_cselect_b64 s[40:41], s[60:61], s[78:79]
s_cmp_ge_u32 s3, 2
s_cselect_b64 s[12:13], s[56:57], s[54:55]
s_mov_b32 s14, 819200
s_mov_b32 s15, 0x20000
s_mov_b32 s16, s86
s_mov_b32 s17, s87
s_mov_b32 s18, 17039488
s_mov_b32 s19, 0x20000
s_mul_i32 s97, s89, 10240
s_add_u32 s97, s97, 10485760
s_add_u32 s20, s86, s97
s_addc_u32 s21, s87, 0
s_mov_b32 s22, 10240
s_mov_b32 s23, 0x20000
s_mov_b32 s24, s84
s_mov_b32 s25, s85
s_mov_b32 s26, 256
s_mov_b32 s27, 0x20000
s_mov_b32 s28, s82
s_mov_b32 s29, s83
s_mov_b32 s30, 5242880
s_mov_b32 s31, 0x20000
s_mov_b32 s32, s80
s_mov_b32 s33, s81
v_mov_b32 v4, 0x7ff00000
v_lshl_or_b32 v2, s2, 8, v0
v_cmp_eq_u32 vcc, 0, v2
v_mov_b32 v3, 10747904
s_sub_u32 s97, 15, s88
v_cndmask_b32 v176, v4, v3, vcc
v_cndmask_b32 v177, v4, v2, vcc
buffer_load_dword v186, v176, s[16:19], 0 offen sc1
s_mul_i32 s97, s97, 640
v_lshlrev_b32 v2, 3, v10
v_add_u32 v2, s97, v2
v_cmp_gt_u32 vcc, 20, v1
s_lshl_b32 s97, s88, 7
s_lshl_b32 s98, s89, 3
v_cndmask_b32 v196, v4, v2, vcc
v_mov_b32 v14, -1
v_mov_b32 v15, -1
buffer_store_dwordx2 v[14:15], v196, s[20:23], 0 offen sc1
s_add_u32 s97, s97, s98
s_lshl_b32 s98, s3, 1
s_add_u32 s97, s97, s98
v_lshrrev_b32 v2, 5, v1
v_add_u32 v8, s97, v2
v_lshlrev_b32 v2, 4, v8
v_add_u32 v2, 10649600, v2
v_and_b32 v3, 31, v1
v_cmp_eq_u32 vcc, 0, v3
s_lshl_b32 s97, s88, 4
s_add_u32 s97, s97, s89
v_cndmask_b32 v197, v4, v2, vcc
s_lshl_b32 s97, s97, 7
s_add_u32 s97, s97, 10682368
v_mov_b32 v2, s97
v_cmp_eq_u32 vcc, 0, v0
s_mov_b32 s53, 32768
s_mov_b32 s100, 0
v_cndmask_b32 v198, v4, v2, vcc
v_and_b32 v2, 15, v1
v_lshrrev_b32 v3, 1, v2
v_lshrrev_b32 v4, 4, v1
v_xor_b32 v3, v3, v4
v_lshlrev_b32 v3, 4, v3
v_lshl_add_u32 v2, v2, 7, v3
v_xor_b32 v3, 64, v2
v_add_u32 v156, s92, v2
v_add_u32 v164, 16384, v2
v_add_u32 v180, s94, v2
v_add_u32 v157, 40960, v156
v_add_u32 v165, 40960, v164
v_add_u32 v158, 81920, v156
v_add_u32 v166, 81920, v164
v_add_u32 v159, 122880, v156
v_add_u32 v167, 122880, v164
v_add_u32 v181, 81920, v180
v_add_u32 v182, 122880, v180
v_add_u32 v160, s92, v3
v_add_u32 v168, 16384, v3
v_add_u32 v183, s94, v3
v_add_u32 v161, 40960, v160
v_add_u32 v169, 40960, v168
v_add_u32 v162, 81920, v160
v_add_u32 v170, 81920, v168
v_add_u32 v163, 122880, v160
v_add_u32 v171, 122880, v168
v_add_u32 v184, 81920, v183
v_add_u32 v185, 122880, v183
s_mul_i32 s97, s91, 102400
s_and_b32 s98, s3, 1
s_mul_i32 s98, s98, 640
s_add_u32 s97, s97, s98
v_add_u32 v238, s97, v7
v_xor_b32 v7, 64, v238
v_add_u32 v239, 9216, v7
v_add_u32 v240, 18432, v238
v_add_u32 v241, 27648, v7
v_add_u32 v242, 40960, v238
v_add_u32 v243, 50176, v7
v_add_u32 v244, 59392, v238
v_add_u32 v245, 68608, v7
v_add_u32 v246, 81920, v238
v_add_u32 v247, 91136, v7
s_lshr_b32 s101, s101, 1
s_mul_i32 s101, s101, 1
s_and_b32 s97, s89, 3
s_mul_i32 s97, s97, 1
s_add_u32 s101, s101, s97
s_mul_i32 s97, s91, 1
s_add_u32 s101, s101, s97
s_mul_i32 s97, s101, 13108
s_lshr_b32 s97, s97, 16
s_mul_i32 s97, s97, 5
s_sub_u32 s101, s101, s97
s_mul_i32 s97, s3, 3072
s_add_u32 s97, s97, 10748032
s_mul_i32 s49, s2, 24576
s_add_u32 s49, s49, s97
s_add_u32 s50, s49, 12288
s_xor_b32 s51, s2, 1
s_mul_i32 s51, s51, 24576
s_add_u32 s51, s51, s97
s_add_u32 s52, s51, 12288
v_cmp_gt_u32 vcc, 32, v1
v_lshlrev_b32 v178, 4, v1
v_mov_b32 v4, 0x7ff00000
s_nop 0
v_cndmask_b32 v179, v4, v178, vcc
s_lshl_b32 s96, s101, 7
v_and_b32 v2, 15, v1
v_lshrrev_b32 v3, 4, v1
v_bfe_u32 v4, v2, 1, 2
v_xor_b32 v4, v4, v3
v_bfe_u32 v5, v2, 3, 1
v_lshlrev_b32 v5, 1, v5
v_xor_b32 v4, v4, v5
v_lshlrev_b32 v4, 4, v4
s_lshl_b32 s97, s3, 11
s_add_u32 s97, s97, 64000
v_lshl_add_u32 v4, v2, 6, v4
v_add_u32 v7, s97, v4
v_accvgpr_write_b32 a200, v7
v_lshrrev_b32 v4, 2, v2
v_lshl_add_u32 v5, v3, 3, v4
v_lshlrev_b32 v5, 6, v5
v_lshrrev_b32 v4, 1, v4
v_bfe_u32 v6, v2, 1, 1
v_xor_b32 v4, v4, v6
v_lshl_add_u32 v5, v4, 4, v5
v_and_b32 v4, 1, v2
v_lshl_add_u32 v5, v4, 3, v5
v_and_b32 v4, 1, v3
v_lshl_add_u32 v5, v4, 5, v5
v_add_u32 v7, s97, v5
v_accvgpr_write_b32 a201, v7
v_xor_b32 v7, 32, v7
v_accvgpr_write_b32 a202, v7
v_and_b32 v4, 31, v1
v_lshlrev_b32 v4, 4, v4
v_lshrrev_b32 v5, 5, v1
v_mul_u32_u24 v5, 2621440, v5
v_add_u32 v7, v4, v5
v_accvgpr_write_b32 a203, v7
s_lshr_b32 s97, s89, 3
s_mul_i32 s54, s97, 5242880
s_lshl_b32 s97, s88, 3
s_lshl_b32 s98, s3, 1
s_add_u32 s97, s97, s98
s_mul_i32 s97, s97, 20480
s_add_u32 s54, s54, s97
s_and_b32 s97, s89, 7
s_mul_i32 s97, s97, 2560
s_add_u32 s54, s54, s97
s_add_u32 s55, s54, 20480
s_and_b32 s97, s2, 1
s_lshl_b32 s97, s97, 1
s_sub_u32 s97, 2, s97
v_bfe_u32 v15, v1, 3, 2
v_add_u32 v15, s97, v15
v_and_b32 v15, 3, v15
s_and_b32 s97, s97, 3
s_mul_i32 s58, s97, 40960
s_add_u32 s59, s58, 20480
s_add_u32 s97, s97, 1
s_and_b32 s97, s97, 3
s_mul_i32 s60, s97, 40960
s_add_u32 s61, s60, 20480
s_add_u32 s97, s97, 1
s_and_b32 s97, s97, 3
s_mul_i32 s62, s97, 40960
s_add_u32 s63, s62, 20480
s_lshl_b32 s66, s62, 1
s_add_u32 s97, s97, 1
s_and_b32 s97, s97, 3
s_mul_i32 s64, s97, 40960
s_add_u32 s65, s64, 20480
s_lshl_b32 s67, s64, 1
s_add_u32 s97, s97, 1
s_lshl_b32 s98, s3, 3
s_lshl_b32 s97, s89, 7
s_add_u32 s97, s97, s98
v_and_b32 v2, 7, v1
v_lshl_add_u32 v2, v15, 5, v2
v_add_u32 v2, s97, v2
v_lshlrev_b32 v2, 4, v2
v_add_u32 v2, 10649600, v2
v_accvgpr_write_b32 a210, v2
s_mul_i32 s99, s91, 160
v_cmp_gt_u32 vcc, 32, v1
v_mov_b32 v2, v1
v_mul_u32_u24 v3, 205, v2
v_lshrrev_b32 v3, 12, v3
v_mul_u32_u24 v4, 20, v3
v_sub_u32 v4, v2, v4
v_lshlrev_b32 v6, 2, v3
v_accvgpr_write_b32 a211, v6
v_lshl_add_u32 v6, v4, 3, s99
v_accvgpr_write_b32 a204, v6
v_add_u32 v5, s97, v3
v_mul_u32_u24 v5, 1280, v5
v_add_u32 v5, v5, v6
v_accvgpr_write_b32 a207, v5
v_lshlrev_b32 v194, 1, v5
v_add_u32 v3, s98, v3
v_bfe_u32 v5, v3, 1, 2
v_xor_b32 v5, v5, v4
v_lshlrev_b32 v5, 4, v5
v_mul_u32_u24 v3, 320, v3
v_add_u32 v192, v3, v5
v_add_u32 v2, 64, v1
v_mul_u32_u24 v3, 205, v2
v_lshrrev_b32 v3, 12, v3
v_mul_u32_u24 v4, 20, v3
v_sub_u32 v4, v2, v4
v_lshlrev_b32 v6, 2, v3
v_accvgpr_write_b32 a212, v6
v_lshl_add_u32 v6, v4, 3, s99
v_accvgpr_write_b32 a205, v6
v_add_u32 v5, s97, v3
v_mul_u32_u24 v5, 1280, v5
v_add_u32 v5, v5, v6
v_accvgpr_write_b32 a208, v5
v_lshlrev_b32 v195, 1, v5
v_add_u32 v3, s98, v3
v_bfe_u32 v5, v3, 1, 2
v_xor_b32 v5, v5, v4
v_lshlrev_b32 v5, 4, v5
v_mul_u32_u24 v3, 320, v3
v_add_u32 v193, v3, v5
v_min_u32 v2, 31, v1
v_add_u32 v2, 128, v2
v_mul_u32_u24 v3, 205, v2
v_lshrrev_b32 v3, 12, v3
v_mul_u32_u24 v4, 20, v3
v_sub_u32 v4, v2, v4
v_lshlrev_b32 v6, 2, v3
v_accvgpr_write_b32 a213, v6
v_lshl_add_u32 v6, v4, 3, s99
v_accvgpr_write_b32 a206, v6
v_add_u32 v5, s97, v3
v_mul_u32_u24 v5, 1280, v5
v_add_u32 v5, v5, v6
v_accvgpr_write_b32 a209, v5
v_lshlrev_b32 v188, 1, v5
v_add_u32 v3, s98, v3
v_bfe_u32 v5, v3, 1, 2
v_xor_b32 v5, v5, v4
v_lshlrev_b32 v5, 4, v5
v_mul_u32_u24 v3, 320, v3
v_add_u32 v189, v3, v5
v_mov_b32 v6, 0x7ff00000
v_cndmask_b32 v188, v6, v188, vcc
v_and_b32 v2, 15, v1
v_lshrrev_b32 v3, 4, v1
v_bfe_u32 v4, v2, 1, 2
v_xor_b32 v3, v3, v4
v_lshlrev_b32 v3, 4, v3
v_mul_u32_u24 v2, 320, v2
v_add3_u32 v191, v2, v3, s94
s_and_b32 s98, s2, 1
s_lshl_b32 s98, s98, 1
s_lshr_b32 s99, s3, 1
s_add_u32 s98, s98, s99
s_mul_i32 s98, s98, 2621440
s_mul_i32 s99, s89, 163840
s_add_u32 s98, s98, s99
s_and_b32 s99, s3, 1
s_mul_i32 s99, s99, 10240
s_add_u32 s98, s98, s99
v_lshl_add_u32 v199, v1, 4, s98
v_add_u32 v190, s58, v199
s_lshl_b32 s44, s101, 11
s_add_u32 s45, s44, 2048
s_cmp_eq_u32 s45, 10240
s_cselect_b32 s45, 0, s45
s_add_u32 s46, s45, 2048
s_cmp_eq_u32 s46, 10240
s_cselect_b32 s46, 0, s46
s_add_u32 s47, s46, 2048
s_cmp_eq_u32 s47, 10240
s_cselect_b32 s47, 0, s47
s_add_u32 s48, s47, 2048
s_cmp_eq_u32 s48, 10240
s_cselect_b32 s48, 0, s48
s_lshl_b32 s97, s89, 4
v_add_u32 v2, s97, v1
s_xor_b32 s97, s88, 8
s_lshl_b32 s97, s97, 4
s_add_u32 s97, s97, s89
v_cmp_gt_u32 vcc, 16, v1
v_mov_b32 v3, s97
s_nop 0
v_cndmask_b32 v2, v3, v2, vcc
v_lshlrev_b32 v2, 7, v2
v_add_u32 v2, 10682368, v2
v_accvgpr_write_b32 a216, v2
v_min_u32 v2, 15, v1
s_lshl_b32 s97, s89, 7
s_add_u32 s97, s97, 10715136
v_lshl_add_u32 v2, v2, 11, s97
v_accvgpr_write_b32 a214, v2
s_sub_u32 s97, 16, s88
s_mul_i32 s97, s97, 640
v_lshl_add_u32 v2, v10, 3, s97
v_accvgpr_write_b32 a215, v2
v_mul_u32_u24 v2, 144, v10
v_add_u32 v2, 52480, v2
s_lshl_b32 s97, s3, 11
s_add_u32 s97, s97, 64000
v_cmp_gt_u32 vcc, 20, v1
v_lshl_add_u32 v3, v1, 4, s97
s_nop 0
v_cndmask_b32 v2, v3, v2, vcc
v_accvgpr_write_b32 a217, v2
s_mov_b32 s56, 3840
s_mov_b32 s57, 7680
s_mov_b32 s97, 0x3fb8aa3b
s_mov_b32 s98, 0x32a5705f
s_mov_b32 s99, 0x3f317218
s_waitcnt vmcnt(11)
v_lshlrev_b32 v13, 16, v13
v_lshlrev_b32 v16, 16, v11
v_lshlrev_b32 v17, 16, v12
v_mul_f32 v2, s97, v13
v_fma_f32 v3, v13, s97, -v2
v_exp_f32 v2, v2
v_fma_f32 v3, v13, s98, v3
v_mul_f32 v3, s99, v3
v_fma_f32 v13, v2, v3, v2
v_cvt_pk_bf16_f32 v13, v13, v13
v_lshlrev_b32 v13, 16, v13
v_mul_f32 v11, v13, v16
v_mul_f32 v12, v13, v17
v_mul_f32 v2, s97, v11
v_fma_f32 v3, v11, s97, -v2
v_exp_f32 v2, v2
v_fma_f32 v3, v11, s98, v3
v_mul_f32 v3, s99, v3
v_fma_f32 v11, v2, v3, v2
v_mul_f32 v12, 0.15915494, v12
v_rndne_f32 v2, v12
v_sub_f32 v12, v12, v2
v_cos_f32 v2, v12
v_sin_f32 v3, v12
v_mul_f32 v4, v16, v16
v_fmac_f32 v4, v17, v17
v_mul_f32 v18, v11, v2
v_mul_f32 v19, v11, v3
v_rcp_f32 v4, v4
v_pk_mul_f32 v[22:23], v[18:19], v[18:19] op_sel_hi:[0,1]
v_pk_fma_f32 v[22:23], v[18:19], v[18:19], v[22:23] op_sel:[1,1,0] op_sel_hi:[1,0,1] neg_lo:[0,1,0]
v_pk_mul_f32 v[20:21], v[22:23], v[22:23] op_sel_hi:[0,1]
v_pk_fma_f32 v[20:21], v[22:23], v[22:23], v[20:21] op_sel:[1,1,0] op_sel_hi:[1,0,1] neg_lo:[0,1,0]
v_pk_mul_f32 v[232:233], v[20:21], v[20:21] op_sel_hi:[0,1]
v_pk_fma_f32 v[232:233], v[20:21], v[20:21], v[232:233] op_sel:[1,1,0] op_sel_hi:[1,0,1] neg_lo:[0,1,0]
v_pk_mul_f32 v[22:23], v[232:233], v[232:233] op_sel_hi:[0,1]
v_pk_fma_f32 v[22:23], v[232:233], v[232:233], v[22:23] op_sel:[1,1,0] op_sel_hi:[1,0,1] neg_lo:[0,1,0]
v_pk_mul_f32 v[24:25], v[22:23], v[22:23] op_sel_hi:[0,1]
v_pk_fma_f32 v[24:25], v[22:23], v[22:23], v[24:25] op_sel:[1,1,0] op_sel_hi:[1,0,1] neg_lo:[0,1,0]
v_pk_mul_f32 v[22:23], v[24:25], v[24:25] op_sel_hi:[0,1]
v_pk_fma_f32 v[22:23], v[24:25], v[24:25], v[22:23] op_sel:[1,1,0] op_sel_hi:[1,0,1] neg_lo:[0,1,0]
v_pk_mul_f32 v[234:235], v[22:23], v[22:23] op_sel_hi:[0,1]
v_pk_fma_f32 v[234:235], v[22:23], v[22:23], v[234:235] op_sel:[1,1,0] op_sel_hi:[1,0,1] neg_lo:[0,1,0]
v_add_f32 v4, v4, v4
v_add_f32 v2, -1.0, v18
v_mul_f32 v6, v2, v16
v_fmac_f32 v6, v19, v17
v_mul_f32 v7, v19, v16
v_fma_f32 v7, -v2, v17, v7
v_mul_f32 v236, v4, v6
v_mul_f32 v237, v4, v7
v_lshlrev_b32 v2, 5, v10
v_add_u32 v2, 77824, v2
s_mov_b64 exec, 0xfffff
ds_write_b128 v2, v[18:21]
ds_write_b64 v2, v[236:237] offset:16
s_mov_b64 exec, -1
v_and_b32 v9, 15, v1
v_lshlrev_b32 v9, 5, v9
v_add_u32 v9, 77824, v9
v_and_b32 v2, 15, v1
v_mul_u32_u24 v2, 144, v2
v_lshrrev_b32 v3, 4, v1
v_lshl_add_u32 v2, v3, 3, v2
s_lshl_b32 s97, s3, 5
s_add_u32 s97, s97, 40960
v_add_u32 v12, s97, v2
v_mul_u32_u24 v13, 144, v10
v_add_u32 v13, 40960, v13
v_and_b32 v2, 31, v1
v_lshlrev_b32 v6, 4, v2
v_mul_u32_u24 v4, 1280, v8
v_cmp_gt_u32 vcc, 16, v2
v_add_u32 v4, v4, v6
v_mov_b32 v3, 0x7ff00000
s_mov_b32 s97, 0xffff0000
v_cndmask_b32 v5, v3, v4, vcc
v_cndmask_b32 v7, v3, v6, vcc
s_add_u32 m0, s92, 40960
s_nop 0
buffer_load_dwordx4 v172, s[4:7], s95 offen offset:0  lds
buffer_load_dwordx4 v173, s[4:7], s95 offen offset:1024  lds
buffer_load_dwordx4 v174, s[4:7], s95 offen offset:2048  lds
buffer_load_dwordx4 v175, s[4:7], s95 offen offset:3072  lds
s_add_u32 m0, s93, 40960
s_nop 0
buffer_load_dwordx4 v248, s[8:11], s95 offen offset:0  lds
buffer_load_dwordx4 v249, s[8:11], s95 offen offset:1024  lds
buffer_load_dwordx4 v250, s[8:11], s95 offen offset:2048  lds
buffer_load_dwordx4 v251, s[8:11], s95 offen offset:3072  lds
s_add_u32 m0, s93, 45056
s_nop 0
buffer_load_dwordx4 v252, s[8:11], s95 offen offset:0  lds
s_add_u32 s95, s95, 128
s_cmp_eq_u32 s95, 1280
s_cselect_b32 s95, 0, s95
s_add_u32 m0, s92, 81920
s_nop 0
buffer_load_dwordx4 v172, s[4:7], s95 offen offset:0  lds
buffer_load_dwordx4 v173, s[4:7], s95 offen offset:1024  lds
buffer_load_dwordx4 v174, s[4:7], s95 offen offset:2048  lds
buffer_load_dwordx4 v175, s[4:7], s95 offen offset:3072  lds
s_add_u32 m0, s93, 81920
s_nop 0
buffer_load_dwordx4 v248, s[8:11], s95 offen offset:0  lds
buffer_load_dwordx4 v249, s[8:11], s95 offen offset:1024  lds
buffer_load_dwordx4 v250, s[8:11], s95 offen offset:2048  lds
buffer_load_dwordx4 v251, s[8:11], s95 offen offset:3072  lds
s_add_u32 m0, s93, 86016
s_nop 0
buffer_load_dwordx4 v252, s[8:11], s95 offen offset:0  lds
s_add_u32 s95, s95, 128
s_cmp_eq_u32 s95, 1280
s_cselect_b32 s95, 0, s95
s_waitcnt vmcnt(19) lgkmcnt(0)
v_add_u32 v186, 1, v186
v_mov_b32 v187, 1
s_barrier
buffer_store_dwordx2 v[186:187], v177, s[24:27], 0 offen sc1
buffer_store_dword v186, v176, s[16:19], 0 offen sc1
ds_read_b128 v[136:139], v156 offset:0
ds_read_b128 v[96:99], v164 offset:0
ds_read_b128 v[140:143], v156 offset:2048
ds_read_b128 v[100:103], v164 offset:2048
ds_read_b128 v[104:107], v164 offset:4096
ds_read_b128 v[108:111], v164 offset:6144
ds_read_b128 v[112:115], v164 offset:8192
ds_read_b128 v[116:119], v164 offset:10240
ds_read_b128 v[120:123], v164 offset:12288
ds_read_b128 v[124:127], v164 offset:14336
ds_read_b128 v[128:131], v164 offset:16384
ds_read_b128 v[132:135], v164 offset:18432
s_waitcnt lgkmcnt(10)
v_mfma_f32_16x16x32_bf16 v[16:19], v[136:139], v[96:99], 0
ds_read_b128 v[144:147], v160 offset:0
s_add_u32 m0, s92, 122880
s_waitcnt lgkmcnt(10)
v_mfma_f32_16x16x32_bf16 v[56:59], v[140:143], v[96:99], 0
ds_read_b128 v[96:99], v168 offset:0
buffer_load_dwordx4 v172, s[4:7], s95 offen offset:0  lds
s_waitcnt lgkmcnt(10)
v_mfma_f32_16x16x32_bf16 v[20:23], v[136:139], v[100:103], 0
ds_read_b128 v[148:151], v160 offset:2048
v_mfma_f32_16x16x32_bf16 v[60:63], v[140:143], v[100:103], 0
ds_read_b128 v[100:103], v168 offset:2048
buffer_load_dwordx4 v173, s[4:7], s95 offen offset:1024  lds
s_waitcnt lgkmcnt(11)
v_mfma_f32_16x16x32_bf16 v[24:27], v[136:139], v[104:107], 0
v_mfma_f32_16x16x32_bf16 v[64:67], v[140:143], v[104:107], 0
ds_read_b128 v[104:107], v168 offset:4096
buffer_load_dwordx4 v174, s[4:7], s95 offen offset:2048  lds
s_waitcnt lgkmcnt(11)
v_mfma_f32_16x16x32_bf16 v[28:31], v[136:139], v[108:111], 0
v_mfma_f32_16x16x32_bf16 v[68:71], v[140:143], v[108:111], 0
ds_read_b128 v[108:111], v168 offset:6144
buffer_load_dwordx4 v175, s[4:7], s95 offen offset:3072  lds
s_waitcnt lgkmcnt(5)
v_mfma_f32_16x16x32_bf16 v[32:35], v[136:139], v[112:115], 0
s_add_u32 m0, s93, 122880
v_mfma_f32_16x16x32_bf16 v[72:75], v[140:143], v[112:115], 0
ds_read_b128 v[112:115], v168 offset:8192
buffer_load_dwordx4 v248, s[8:11], s95 offen offset:0  lds
v_mfma_f32_16x16x32_bf16 v[36:39], v[136:139], v[116:119], 0
v_mfma_f32_16x16x32_bf16 v[76:79], v[140:143], v[116:119], 0
ds_read_b128 v[116:119], v168 offset:10240
buffer_load_dwordx4 v249, s[8:11], s95 offen offset:1024  lds
v_mfma_f32_16x16x32_bf16 v[40:43], v[136:139], v[120:123], 0
v_mfma_f32_16x16x32_bf16 v[80:83], v[140:143], v[120:123], 0
ds_read_b128 v[120:123], v168 offset:12288
buffer_load_dwordx4 v250, s[8:11], s95 offen offset:2048  lds
v_mfma_f32_16x16x32_bf16 v[44:47], v[136:139], v[124:127], 0
v_mfma_f32_16x16x32_bf16 v[84:87], v[140:143], v[124:127], 0
ds_read_b128 v[124:127], v168 offset:14336
buffer_load_dwordx4 v251, s[8:11], s95 offen offset:3072  lds
v_mfma_f32_16x16x32_bf16 v[48:51], v[136:139], v[128:131], 0
s_add_u32 m0, s93, 126976
v_mfma_f32_16x16x32_bf16 v[88:91], v[140:143], v[128:131], 0
ds_read_b128 v[128:131], v168 offset:16384
buffer_load_dwordx4 v252, s[8:11], s95 offen offset:0  lds
v_mfma_f32_16x16x32_bf16 v[52:55], v[136:139], v[132:135], 0
s_add_u32 s95, s95, 128
s_cmp_eq_u32 s95, 1280
s_cselect_b32 s95, 0, s95
v_mfma_f32_16x16x32_bf16 v[92:95], v[140:143], v[132:135], 0
ds_read_b128 v[132:135], v168 offset:18432
s_waitcnt lgkmcnt(4)
v_mfma_f32_16x16x32_bf16 v[16:19], v[144:147], v[96:99], v[16:19]
v_mfma_f32_16x16x32_bf16 v[56:59], v[148:151], v[96:99], v[56:59]
v_mfma_f32_16x16x32_bf16 v[20:23], v[144:147], v[100:103], v[20:23]
v_mfma_f32_16x16x32_bf16 v[60:63], v[148:151], v[100:103], v[60:63]
v_mfma_f32_16x16x32_bf16 v[24:27], v[144:147], v[104:107], v[24:27]
v_mfma_f32_16x16x32_bf16 v[64:67], v[148:151], v[104:107], v[64:67]
s_waitcnt vmcnt(20) lgkmcnt(0)
s_barrier
v_mfma_f32_16x16x32_bf16 v[28:31], v[144:147], v[108:111], v[28:31]
ds_read_b128 v[136:139], v157 offset:0
s_add_u32 m0, s92, 0
v_mfma_f32_16x16x32_bf16 v[68:71], v[148:151], v[108:111], v[68:71]
ds_read_b128 v[96:99], v165 offset:0
buffer_load_dwordx4 v172, s[4:7], s95 offen offset:0  lds
v_mfma_f32_16x16x32_bf16 v[32:35], v[144:147], v[112:115], v[32:35]
ds_read_b128 v[140:143], v157 offset:2048
v_mfma_f32_16x16x32_bf16 v[72:75], v[148:151], v[112:115], v[72:75]
ds_read_b128 v[100:103], v165 offset:2048
v_mfma_f32_16x16x32_bf16 v[36:39], v[144:147], v[116:119], v[36:39]
ds_read_b128 v[104:107], v165 offset:4096
v_mfma_f32_16x16x32_bf16 v[76:79], v[148:151], v[116:119], v[76:79]
ds_read_b128 v[108:111], v165 offset:6144
buffer_load_dwordx4 v173, s[4:7], s95 offen offset:1024  lds
v_mfma_f32_16x16x32_bf16 v[40:43], v[144:147], v[120:123], v[40:43]
ds_read_b128 v[112:115], v165 offset:8192
v_mfma_f32_16x16x32_bf16 v[80:83], v[148:151], v[120:123], v[80:83]
ds_read_b128 v[116:119], v165 offset:10240
v_mfma_f32_16x16x32_bf16 v[44:47], v[144:147], v[124:127], v[44:47]
ds_read_b128 v[120:123], v165 offset:12288
v_mfma_f32_16x16x32_bf16 v[84:87], v[148:151], v[124:127], v[84:87]
ds_read_b128 v[124:127], v165 offset:14336
buffer_load_dwordx4 v174, s[4:7], s95 offen offset:2048  lds
v_mfma_f32_16x16x32_bf16 v[48:51], v[144:147], v[128:131], v[48:51]
v_mfma_f32_16x16x32_bf16 v[88:91], v[148:151], v[128:131], v[88:91]
ds_read_b128 v[128:131], v165 offset:16384
v_mfma_f32_16x16x32_bf16 v[52:55], v[144:147], v[132:135], v[52:55]
v_mfma_f32_16x16x32_bf16 v[92:95], v[148:151], v[132:135], v[92:95]
ds_read_b128 v[132:135], v165 offset:18432
buffer_load_dwordx4 v175, s[4:7], s95 offen offset:3072  lds
s_waitcnt lgkmcnt(5)
v_mfma_f32_16x16x32_bf16 v[16:19], v[136:139], v[96:99], v[16:19]
ds_read_b128 v[144:147], v161 offset:0
v_mfma_f32_16x16x32_bf16 v[56:59], v[140:143], v[96:99], v[56:59]
ds_read_b128 v[96:99], v169 offset:0
v_mfma_f32_16x16x32_bf16 v[20:23], v[136:139], v[100:103], v[20:23]
ds_read_b128 v[148:151], v161 offset:2048
v_mfma_f32_16x16x32_bf16 v[60:63], v[140:143], v[100:103], v[60:63]
ds_read_b128 v[100:103], v169 offset:2048
s_add_u32 m0, s93, 0
v_mfma_f32_16x16x32_bf16 v[24:27], v[136:139], v[104:107], v[24:27]
buffer_load_dwordx4 v248, s[8:11], s95 offen offset:0  lds
v_mfma_f32_16x16x32_bf16 v[64:67], v[140:143], v[104:107], v[64:67]
ds_read_b128 v[104:107], v169 offset:4096
v_mfma_f32_16x16x32_bf16 v[28:31], v[136:139], v[108:111], v[28:31]
v_mfma_f32_16x16x32_bf16 v[68:71], v[140:143], v[108:111], v[68:71]
ds_read_b128 v[108:111], v169 offset:6144
v_mfma_f32_16x16x32_bf16 v[32:35], v[136:139], v[112:115], v[32:35]
buffer_load_dwordx4 v249, s[8:11], s95 offen offset:1024  lds
v_mfma_f32_16x16x32_bf16 v[72:75], v[140:143], v[112:115], v[72:75]
ds_read_b128 v[112:115], v169 offset:8192
s_waitcnt lgkmcnt(4)
v_mfma_f32_16x16x32_bf16 v[36:39], v[136:139], v[116:119], v[36:39]
v_mfma_f32_16x16x32_bf16 v[76:79], v[140:143], v[116:119], v[76:79]
ds_read_b128 v[116:119], v169 offset:10240
v_mfma_f32_16x16x32_bf16 v[40:43], v[136:139], v[120:123], v[40:43]
buffer_load_dwordx4 v250, s[8:11], s95 offen offset:2048  lds
v_mfma_f32_16x16x32_bf16 v[80:83], v[140:143], v[120:123], v[80:83]
ds_read_b128 v[120:123], v169 offset:12288
v_mfma_f32_16x16x32_bf16 v[44:47], v[136:139], v[124:127], v[44:47]
v_mfma_f32_16x16x32_bf16 v[84:87], v[140:143], v[124:127], v[84:87]
ds_read_b128 v[124:127], v169 offset:14336
v_mfma_f32_16x16x32_bf16 v[48:51], v[136:139], v[128:131], v[48:51]
buffer_load_dwordx4 v251, s[8:11], s95 offen offset:3072  lds
v_mfma_f32_16x16x32_bf16 v[88:91], v[140:143], v[128:131], v[88:91]
ds_read_b128 v[128:131], v169 offset:16384
v_mfma_f32_16x16x32_bf16 v[52:55], v[136:139], v[132:135], v[52:55]
v_mfma_f32_16x16x32_bf16 v[92:95], v[140:143], v[132:135], v[92:95]
ds_read_b128 v[132:135], v169 offset:18432
v_mfma_f32_16x16x32_bf16 v[16:19], v[144:147], v[96:99], v[16:19]
s_add_u32 m0, s93, 4096
v_mfma_f32_16x16x32_bf16 v[56:59], v[148:151], v[96:99], v[56:59]
buffer_load_dwordx4 v252, s[8:11], s95 offen offset:0  lds
s_waitcnt lgkmcnt(3)
v_mfma_f32_16x16x32_bf16 v[20:23], v[144:147], v[100:103], v[20:23]
s_add_u32 s95, s95, 128
s_cmp_eq_u32 s95, 1280
s_cselect_b32 s95, 0, s95
v_mfma_f32_16x16x32_bf16 v[60:63], v[148:151], v[100:103], v[60:63]
v_mfma_f32_16x16x32_bf16 v[24:27], v[144:147], v[104:107], v[24:27]
v_mfma_f32_16x16x32_bf16 v[64:67], v[148:151], v[104:107], v[64:67]
s_waitcnt vmcnt(20) lgkmcnt(0)
s_barrier
v_mfma_f32_16x16x32_bf16 v[28:31], v[144:147], v[108:111], v[28:31]
ds_read_b128 v[136:139], v158 offset:0
s_add_u32 m0, s92, 40960
v_mfma_f32_16x16x32_bf16 v[68:71], v[148:151], v[108:111], v[68:71]
ds_read_b128 v[96:99], v166 offset:0
buffer_load_dwordx4 v172, s[4:7], s95 offen offset:0  lds
v_mfma_f32_16x16x32_bf16 v[32:35], v[144:147], v[112:115], v[32:35]
ds_read_b128 v[140:143], v158 offset:2048
v_mfma_f32_16x16x32_bf16 v[72:75], v[148:151], v[112:115], v[72:75]
ds_read_b128 v[100:103], v166 offset:2048
v_mfma_f32_16x16x32_bf16 v[36:39], v[144:147], v[116:119], v[36:39]
ds_read_b128 v[104:107], v166 offset:4096
v_mfma_f32_16x16x32_bf16 v[76:79], v[148:151], v[116:119], v[76:79]
ds_read_b128 v[108:111], v166 offset:6144
buffer_load_dwordx4 v173, s[4:7], s95 offen offset:1024  lds
v_mfma_f32_16x16x32_bf16 v[40:43], v[144:147], v[120:123], v[40:43]
ds_read_b128 v[112:115], v166 offset:8192
v_mfma_f32_16x16x32_bf16 v[80:83], v[148:151], v[120:123], v[80:83]
ds_read_b128 v[116:119], v166 offset:10240
v_mfma_f32_16x16x32_bf16 v[44:47], v[144:147], v[124:127], v[44:47]
ds_read_b128 v[120:123], v166 offset:12288
v_mfma_f32_16x16x32_bf16 v[84:87], v[148:151], v[124:127], v[84:87]
ds_read_b128 v[124:127], v166 offset:14336
buffer_load_dwordx4 v174, s[4:7], s95 offen offset:2048  lds
v_mfma_f32_16x16x32_bf16 v[48:51], v[144:147], v[128:131], v[48:51]
buffer_load_dwordx4 v[212:215], v6, s[32:35], 0 offen offset:0
v_mfma_f32_16x16x32_bf16 v[88:91], v[148:151], v[128:131], v[88:91]
ds_read_b128 v[128:131], v166 offset:16384
v_mfma_f32_16x16x32_bf16 v[52:55], v[144:147], v[132:135], v[52:55]
v_mfma_f32_16x16x32_bf16 v[92:95], v[148:151], v[132:135], v[92:95]
ds_read_b128 v[132:135], v166 offset:18432
buffer_load_dwordx4 v175, s[4:7], s95 offen offset:3072  lds
s_waitcnt lgkmcnt(5)
v_mfma_f32_16x16x32_bf16 v[16:19], v[136:139], v[96:99], v[16:19]
ds_read_b128 v[144:147], v162 offset:0
v_mfma_f32_16x16x32_bf16 v[56:59], v[140:143], v[96:99], v[56:59]
ds_read_b128 v[96:99], v170 offset:0
v_mfma_f32_16x16x32_bf16 v[20:23], v[136:139], v[100:103], v[20:23]
ds_read_b128 v[148:151], v162 offset:2048
v_mfma_f32_16x16x32_bf16 v[60:63], v[140:143], v[100:103], v[60:63]
ds_read_b128 v[100:103], v170 offset:2048
s_add_u32 m0, s93, 40960
v_mfma_f32_16x16x32_bf16 v[24:27], v[136:139], v[104:107], v[24:27]
buffer_load_dwordx4 v248, s[8:11], s95 offen offset:0  lds
v_mfma_f32_16x16x32_bf16 v[64:67], v[140:143], v[104:107], v[64:67]
ds_read_b128 v[104:107], v170 offset:4096
v_mfma_f32_16x16x32_bf16 v[28:31], v[136:139], v[108:111], v[28:31]
v_mfma_f32_16x16x32_bf16 v[68:71], v[140:143], v[108:111], v[68:71]
ds_read_b128 v[108:111], v170 offset:6144
v_mfma_f32_16x16x32_bf16 v[32:35], v[136:139], v[112:115], v[32:35]
buffer_load_dwordx4 v249, s[8:11], s95 offen offset:1024  lds
v_mfma_f32_16x16x32_bf16 v[72:75], v[140:143], v[112:115], v[72:75]
ds_read_b128 v[112:115], v170 offset:8192
s_waitcnt lgkmcnt(4)
v_mfma_f32_16x16x32_bf16 v[36:39], v[136:139], v[116:119], v[36:39]
buffer_load_dwordx4 v[200:203], v4, s[4:7], 0 offen offset:0
v_mfma_f32_16x16x32_bf16 v[76:79], v[140:143], v[116:119], v[76:79]
ds_read_b128 v[116:119], v170 offset:10240
v_mfma_f32_16x16x32_bf16 v[40:43], v[136:139], v[120:123], v[40:43]
buffer_load_dwordx4 v250, s[8:11], s95 offen offset:2048  lds
v_mfma_f32_16x16x32_bf16 v[80:83], v[140:143], v[120:123], v[80:83]
ds_read_b128 v[120:123], v170 offset:12288
v_mfma_f32_16x16x32_bf16 v[44:47], v[136:139], v[124:127], v[44:47]
v_mfma_f32_16x16x32_bf16 v[84:87], v[140:143], v[124:127], v[84:87]
ds_read_b128 v[124:127], v170 offset:14336
v_mfma_f32_16x16x32_bf16 v[48:51], v[136:139], v[128:131], v[48:51]
buffer_load_dwordx4 v251, s[8:11], s95 offen offset:3072  lds
v_mfma_f32_16x16x32_bf16 v[88:91], v[140:143], v[128:131], v[88:91]
ds_read_b128 v[128:131], v170 offset:16384
v_mfma_f32_16x16x32_bf16 v[52:55], v[136:139], v[132:135], v[52:55]
v_mfma_f32_16x16x32_bf16 v[92:95], v[140:143], v[132:135], v[92:95]
ds_read_b128 v[132:135], v170 offset:18432
v_mfma_f32_16x16x32_bf16 v[16:19], v[144:147], v[96:99], v[16:19]
s_add_u32 m0, s93, 45056
v_mfma_f32_16x16x32_bf16 v[56:59], v[148:151], v[96:99], v[56:59]
buffer_load_dwordx4 v252, s[8:11], s95 offen offset:0  lds
s_waitcnt lgkmcnt(3)
v_mfma_f32_16x16x32_bf16 v[20:23], v[144:147], v[100:103], v[20:23]
s_add_u32 s95, s95, 128
s_cmp_eq_u32 s95, 1280
s_cselect_b32 s95, 0, s95
v_mfma_f32_16x16x32_bf16 v[60:63], v[148:151], v[100:103], v[60:63]
v_mfma_f32_16x16x32_bf16 v[24:27], v[144:147], v[104:107], v[24:27]
buffer_load_dwordx2 v[14:15], off, s[24:27], 0 sc1
v_mfma_f32_16x16x32_bf16 v[64:67], v[148:151], v[104:107], v[64:67]
s_waitcnt vmcnt(21) lgkmcnt(0)
s_barrier
v_mfma_f32_16x16x32_bf16 v[28:31], v[144:147], v[108:111], v[28:31]
ds_read_b128 v[136:139], v159 offset:0
s_add_u32 m0, s92, 81920
v_mfma_f32_16x16x32_bf16 v[68:71], v[148:151], v[108:111], v[68:71]
ds_read_b128 v[96:99], v167 offset:0
buffer_load_dwordx4 v172, s[4:7], s95 offen offset:0  lds
v_mfma_f32_16x16x32_bf16 v[32:35], v[144:147], v[112:115], v[32:35]
ds_read_b128 v[140:143], v159 offset:2048
v_mfma_f32_16x16x32_bf16 v[72:75], v[148:151], v[112:115], v[72:75]
ds_read_b128 v[100:103], v167 offset:2048
v_mfma_f32_16x16x32_bf16 v[36:39], v[144:147], v[116:119], v[36:39]
ds_read_b128 v[104:107], v167 offset:4096
v_mfma_f32_16x16x32_bf16 v[76:79], v[148:151], v[116:119], v[76:79]
ds_read_b128 v[108:111], v167 offset:6144
buffer_load_dwordx4 v173, s[4:7], s95 offen offset:1024  lds
v_mfma_f32_16x16x32_bf16 v[40:43], v[144:147], v[120:123], v[40:43]
ds_read_b128 v[112:115], v167 offset:8192
v_mfma_f32_16x16x32_bf16 v[80:83], v[148:151], v[120:123], v[80:83]
ds_read_b128 v[116:119], v167 offset:10240
v_mfma_f32_16x16x32_bf16 v[44:47], v[144:147], v[124:127], v[44:47]
ds_read_b128 v[120:123], v167 offset:12288
v_mfma_f32_16x16x32_bf16 v[84:87], v[148:151], v[124:127], v[84:87]
ds_read_b128 v[124:127], v167 offset:14336
buffer_load_dwordx4 v174, s[4:7], s95 offen offset:2048  lds
v_mfma_f32_16x16x32_bf16 v[48:51], v[144:147], v[128:131], v[48:51]
buffer_load_dwordx4 v[216:219], v6, s[32:35], 0 offen offset:512
v_mfma_f32_16x16x32_bf16 v[88:91], v[148:151], v[128:131], v[88:91]
ds_read_b128 v[128:131], v167 offset:16384
v_mfma_f32_16x16x32_bf16 v[52:55], v[144:147], v[132:135], v[52:55]
v_mfma_f32_16x16x32_bf16 v[92:95], v[148:151], v[132:135], v[92:95]
ds_read_b128 v[132:135], v167 offset:18432
buffer_load_dwordx4 v175, s[4:7], s95 offen offset:3072  lds
s_waitcnt lgkmcnt(5)
v_mfma_f32_16x16x32_bf16 v[16:19], v[136:139], v[96:99], v[16:19]
ds_read_b128 v[144:147], v163 offset:0
v_mfma_f32_16x16x32_bf16 v[56:59], v[140:143], v[96:99], v[56:59]
ds_read_b128 v[96:99], v171 offset:0
v_mfma_f32_16x16x32_bf16 v[20:23], v[136:139], v[100:103], v[20:23]
ds_read_b128 v[148:151], v163 offset:2048
v_mfma_f32_16x16x32_bf16 v[60:63], v[140:143], v[100:103], v[60:63]
ds_read_b128 v[100:103], v171 offset:2048
s_add_u32 m0, s93, 81920
v_mfma_f32_16x16x32_bf16 v[24:27], v[136:139], v[104:107], v[24:27]
buffer_load_dwordx4 v248, s[8:11], s95 offen offset:0  lds
v_mfma_f32_16x16x32_bf16 v[64:67], v[140:143], v[104:107], v[64:67]
ds_read_b128 v[104:107], v171 offset:4096
v_mfma_f32_16x16x32_bf16 v[28:31], v[136:139], v[108:111], v[28:31]
v_mfma_f32_16x16x32_bf16 v[68:71], v[140:143], v[108:111], v[68:71]
ds_read_b128 v[108:111], v171 offset:6144
v_mfma_f32_16x16x32_bf16 v[32:35], v[136:139], v[112:115], v[32:35]
buffer_load_dwordx4 v249, s[8:11], s95 offen offset:1024  lds
v_mfma_f32_16x16x32_bf16 v[72:75], v[140:143], v[112:115], v[72:75]
ds_read_b128 v[112:115], v171 offset:8192
s_waitcnt lgkmcnt(4)
v_mfma_f32_16x16x32_bf16 v[36:39], v[136:139], v[116:119], v[36:39]
buffer_load_dwordx4 v[204:207], v4, s[4:7], 0 offen offset:512
v_mfma_f32_16x16x32_bf16 v[76:79], v[140:143], v[116:119], v[76:79]
ds_read_b128 v[116:119], v171 offset:10240
v_mfma_f32_16x16x32_bf16 v[40:43], v[136:139], v[120:123], v[40:43]
buffer_load_dwordx4 v250, s[8:11], s95 offen offset:2048  lds
v_mfma_f32_16x16x32_bf16 v[80:83], v[140:143], v[120:123], v[80:83]
ds_read_b128 v[120:123], v171 offset:12288
v_mfma_f32_16x16x32_bf16 v[44:47], v[136:139], v[124:127], v[44:47]
v_mfma_f32_16x16x32_bf16 v[84:87], v[140:143], v[124:127], v[84:87]
ds_read_b128 v[124:127], v171 offset:14336
v_mfma_f32_16x16x32_bf16 v[48:51], v[136:139], v[128:131], v[48:51]
buffer_load_dwordx4 v251, s[8:11], s95 offen offset:3072  lds
v_mfma_f32_16x16x32_bf16 v[88:91], v[140:143], v[128:131], v[88:91]
ds_read_b128 v[128:131], v171 offset:16384
v_mfma_f32_16x16x32_bf16 v[52:55], v[136:139], v[132:135], v[52:55]
v_mfma_f32_16x16x32_bf16 v[92:95], v[140:143], v[132:135], v[92:95]
ds_read_b128 v[132:135], v171 offset:18432
v_mfma_f32_16x16x32_bf16 v[16:19], v[144:147], v[96:99], v[16:19]
s_add_u32 m0, s93, 86016
v_mfma_f32_16x16x32_bf16 v[56:59], v[148:151], v[96:99], v[56:59]
buffer_load_dwordx4 v252, s[8:11], s95 offen offset:0  lds
s_waitcnt lgkmcnt(3)
v_mfma_f32_16x16x32_bf16 v[20:23], v[144:147], v[100:103], v[20:23]
s_add_u32 s95, s95, 128
s_cmp_eq_u32 s95, 1280
s_cselect_b32 s95, 0, s95
v_mfma_f32_16x16x32_bf16 v[60:63], v[148:151], v[100:103], v[60:63]
v_mfma_f32_16x16x32_bf16 v[24:27], v[144:147], v[104:107], v[24:27]
v_mfma_f32_16x16x32_bf16 v[64:67], v[148:151], v[104:107], v[64:67]
s_waitcnt vmcnt(23) lgkmcnt(0)
s_barrier
v_mfma_f32_16x16x32_bf16 v[28:31], v[144:147], v[108:111], v[28:31]
ds_read_b128 v[136:139], v156 offset:0
s_add_u32 m0, s92, 122880
v_mfma_f32_16x16x32_bf16 v[68:71], v[148:151], v[108:111], v[68:71]
ds_read_b128 v[96:99], v164 offset:0
buffer_load_dwordx4 v172, s[4:7], s95 offen offset:0  lds
v_mfma_f32_16x16x32_bf16 v[32:35], v[144:147], v[112:115], v[32:35]
ds_read_b128 v[140:143], v156 offset:2048
s_waitcnt vmcnt(16)
v_mfma_f32_16x16x32_bf16 v[72:75], v[148:151], v[112:115], v[72:75]
ds_read_b128 v[100:103], v164 offset:2048
v_lshlrev_b32 v224, 16, v200
v_mfma_f32_16x16x32_bf16 v[36:39], v[144:147], v[116:119], v[36:39]
ds_read_b128 v[104:107], v164 offset:4096
v_and_b32 v225, s97, v200
v_mfma_f32_16x16x32_bf16 v[76:79], v[148:151], v[116:119], v[76:79]
ds_read_b128 v[108:111], v164 offset:6144
buffer_load_dwordx4 v173, s[4:7], s95 offen offset:1024  lds
v_mfma_f32_16x16x32_bf16 v[40:43], v[144:147], v[120:123], v[40:43]
ds_read_b128 v[112:115], v164 offset:8192
v_lshlrev_b32 v226, 16, v212
v_mfma_f32_16x16x32_bf16 v[80:83], v[148:151], v[120:123], v[80:83]
ds_read_b128 v[116:119], v164 offset:10240
v_and_b32 v227, s97, v212
v_mfma_f32_16x16x32_bf16 v[44:47], v[144:147], v[124:127], v[44:47]
ds_read_b128 v[120:123], v164 offset:12288
v_mul_f32 v224, v224, v226
v_mfma_f32_16x16x32_bf16 v[84:87], v[148:151], v[124:127], v[84:87]
ds_read_b128 v[124:127], v164 offset:14336
buffer_load_dwordx4 v174, s[4:7], s95 offen offset:2048  lds
v_mfma_f32_16x16x32_bf16 v[48:51], v[144:147], v[128:131], v[48:51]
buffer_load_dwordx4 v[220:223], v7, s[32:35], 0 offen offset:1024
v_mfma_f32_16x16x32_bf16 v[88:91], v[148:151], v[128:131], v[88:91]
ds_read_b128 v[128:131], v164 offset:16384
v_mul_f32 v225, v225, v227
v_mfma_f32_16x16x32_bf16 v[52:55], v[144:147], v[132:135], v[52:55]
v_cvt_pk_bf16_f32 v226, v224, v225
v_mfma_f32_16x16x32_bf16 v[92:95], v[148:151], v[132:135], v[92:95]
ds_read_b128 v[132:135], v164 offset:18432
buffer_load_dwordx4 v175, s[4:7], s95 offen offset:3072  lds
s_waitcnt lgkmcnt(5)
v_mfma_f32_16x16x32_bf16 v[16:19], v[136:139], v[96:99], v[16:19]
ds_read_b128 v[144:147], v160 offset:0
v_lshlrev_b32 v229, 16, v226
v_mfma_f32_16x16x32_bf16 v[56:59], v[140:143], v[96:99], v[56:59]
ds_read_b128 v[96:99], v168 offset:0
v_and_b32 v230, s97, v226
v_mfma_f32_16x16x32_bf16 v[20:23], v[136:139], v[100:103], v[20:23]
ds_read_b128 v[148:151], v160 offset:2048
v_lshlrev_b32 v224, 16, v201
v_mfma_f32_16x16x32_bf16 v[60:63], v[140:143], v[100:103], v[60:63]
ds_read_b128 v[100:103], v168 offset:2048
s_add_u32 m0, s93, 122880
v_mfma_f32_16x16x32_bf16 v[24:27], v[136:139], v[104:107], v[24:27]
buffer_load_dwordx4 v248, s[8:11], s95 offen offset:0  lds
v_and_b32 v225, s97, v201
v_mfma_f32_16x16x32_bf16 v[64:67], v[140:143], v[104:107], v[64:67]
ds_read_b128 v[104:107], v168 offset:4096
v_lshlrev_b32 v226, 16, v213
v_mfma_f32_16x16x32_bf16 v[28:31], v[136:139], v[108:111], v[28:31]
v_and_b32 v227, s97, v213
v_mfma_f32_16x16x32_bf16 v[68:71], v[140:143], v[108:111], v[68:71]
ds_read_b128 v[108:111], v168 offset:6144
v_mul_f32 v224, v224, v226
v_mfma_f32_16x16x32_bf16 v[32:35], v[136:139], v[112:115], v[32:35]
buffer_load_dwordx4 v249, s[8:11], s95 offen offset:1024  lds
v_mul_f32 v225, v225, v227
v_mfma_f32_16x16x32_bf16 v[72:75], v[140:143], v[112:115], v[72:75]
ds_read_b128 v[112:115], v168 offset:8192
s_waitcnt lgkmcnt(4)
v_mfma_f32_16x16x32_bf16 v[36:39], v[136:139], v[116:119], v[36:39]
buffer_load_dwordx4 v[208:211], v5, s[4:7], 0 offen offset:1024
v_mfma_f32_16x16x32_bf16 v[76:79], v[140:143], v[116:119], v[76:79]
ds_read_b128 v[116:119], v168 offset:10240
v_cvt_pk_bf16_f32 v226, v224, v225
v_mfma_f32_16x16x32_bf16 v[40:43], v[136:139], v[120:123], v[40:43]
buffer_load_dwordx4 v250, s[8:11], s95 offen offset:2048  lds
v_lshlrev_b32 v224, 16, v226
v_mfma_f32_16x16x32_bf16 v[80:83], v[140:143], v[120:123], v[80:83]
ds_read_b128 v[120:123], v168 offset:12288
v_and_b32 v225, s97, v226
v_mfma_f32_16x16x32_bf16 v[44:47], v[136:139], v[124:127], v[44:47]
v_add_f32 v229, v229, v224
v_mfma_f32_16x16x32_bf16 v[84:87], v[140:143], v[124:127], v[84:87]
ds_read_b128 v[124:127], v168 offset:14336
v_add_f32 v230, v230, v225
v_mfma_f32_16x16x32_bf16 v[48:51], v[136:139], v[128:131], v[48:51]
buffer_load_dwordx4 v251, s[8:11], s95 offen offset:3072  lds
v_lshlrev_b32 v224, 16, v202
v_mfma_f32_16x16x32_bf16 v[88:91], v[140:143], v[128:131], v[88:91]
ds_read_b128 v[128:131], v168 offset:16384
v_and_b32 v225, s97, v202
v_mfma_f32_16x16x32_bf16 v[52:55], v[136:139], v[132:135], v[52:55]
v_lshlrev_b32 v226, 16, v214
v_mfma_f32_16x16x32_bf16 v[92:95], v[140:143], v[132:135], v[92:95]
ds_read_b128 v[132:135], v168 offset:18432
v_and_b32 v227, s97, v214
v_mfma_f32_16x16x32_bf16 v[16:19], v[144:147], v[96:99], v[16:19]
s_add_u32 m0, s93, 126976
v_mul_f32 v224, v224, v226
v_mfma_f32_16x16x32_bf16 v[56:59], v[148:151], v[96:99], v[56:59]
buffer_load_dwordx4 v252, s[8:11], s95 offen offset:0  lds
s_waitcnt lgkmcnt(3)
v_mfma_f32_16x16x32_bf16 v[20:23], v[144:147], v[100:103], v[20:23]
s_add_u32 s95, s95, 128
s_cmp_eq_u32 s95, 1280
s_cselect_b32 s95, 0, s95
v_mfma_f32_16x16x32_bf16 v[60:63], v[148:151], v[100:103], v[60:63]
v_mul_f32 v225, v225, v227
v_mfma_f32_16x16x32_bf16 v[24:27], v[144:147], v[104:107], v[24:27]
v_cvt_pk_bf16_f32 v226, v224, v225
v_mfma_f32_16x16x32_bf16 v[64:67], v[148:151], v[104:107], v[64:67]
s_waitcnt vmcnt(23) lgkmcnt(0)
s_barrier
v_mfma_f32_16x16x32_bf16 v[28:31], v[144:147], v[108:111], v[28:31]
ds_read_b128 v[136:139], v157 offset:0
s_add_u32 m0, s92, 0
v_mfma_f32_16x16x32_bf16 v[68:71], v[148:151], v[108:111], v[68:71]
ds_read_b128 v[96:99], v165 offset:0
buffer_load_dwordx4 v172, s[4:7], s95 offen offset:0  lds
v_mfma_f32_16x16x32_bf16 v[32:35], v[144:147], v[112:115], v[32:35]
ds_read_b128 v[140:143], v157 offset:2048
v_lshlrev_b32 v224, 16, v226
v_mfma_f32_16x16x32_bf16 v[72:75], v[148:151], v[112:115], v[72:75]
ds_read_b128 v[100:103], v165 offset:2048
v_and_b32 v225, s97, v226
v_mfma_f32_16x16x32_bf16 v[36:39], v[144:147], v[116:119], v[36:39]
ds_read_b128 v[104:107], v165 offset:4096
v_add_f32 v229, v229, v224
v_mfma_f32_16x16x32_bf16 v[76:79], v[148:151], v[116:119], v[76:79]
ds_read_b128 v[108:111], v165 offset:6144
buffer_load_dwordx4 v173, s[4:7], s95 offen offset:1024  lds
v_mfma_f32_16x16x32_bf16 v[40:43], v[144:147], v[120:123], v[40:43]
ds_read_b128 v[112:115], v165 offset:8192
v_add_f32 v230, v230, v225
v_mfma_f32_16x16x32_bf16 v[80:83], v[148:151], v[120:123], v[80:83]
ds_read_b128 v[116:119], v165 offset:10240
v_lshlrev_b32 v224, 16, v203
v_mfma_f32_16x16x32_bf16 v[44:47], v[144:147], v[124:127], v[44:47]
ds_read_b128 v[120:123], v165 offset:12288
v_and_b32 v225, s97, v203
v_mfma_f32_16x16x32_bf16 v[84:87], v[148:151], v[124:127], v[84:87]
ds_read_b128 v[124:127], v165 offset:14336
buffer_load_dwordx4 v174, s[4:7], s95 offen offset:2048  lds
v_mfma_f32_16x16x32_bf16 v[48:51], v[144:147], v[128:131], v[48:51]
v_lshlrev_b32 v226, 16, v215
v_mfma_f32_16x16x32_bf16 v[88:91], v[148:151], v[128:131], v[88:91]
ds_read_b128 v[128:131], v165 offset:16384
v_and_b32 v227, s97, v215
v_mfma_f32_16x16x32_bf16 v[52:55], v[144:147], v[132:135], v[52:55]
v_mul_f32 v224, v224, v226
v_mfma_f32_16x16x32_bf16 v[92:95], v[148:151], v[132:135], v[92:95]
ds_read_b128 v[132:135], v165 offset:18432
buffer_load_dwordx4 v175, s[4:7], s95 offen offset:3072  lds
s_waitcnt lgkmcnt(5)
v_mfma_f32_16x16x32_bf16 v[16:19], v[136:139], v[96:99], v[16:19]
ds_read_b128 v[144:147], v161 offset:0
v_mul_f32 v225, v225, v227
v_mfma_f32_16x16x32_bf16 v[56:59], v[140:143], v[96:99], v[56:59]
ds_read_b128 v[96:99], v169 offset:0
v_cvt_pk_bf16_f32 v226, v224, v225
v_mfma_f32_16x16x32_bf16 v[20:23], v[136:139], v[100:103], v[20:23]
ds_read_b128 v[148:151], v161 offset:2048
v_lshlrev_b32 v224, 16, v226
v_mfma_f32_16x16x32_bf16 v[60:63], v[140:143], v[100:103], v[60:63]
ds_read_b128 v[100:103], v169 offset:2048
s_add_u32 m0, s93, 0
v_mfma_f32_16x16x32_bf16 v[24:27], v[136:139], v[104:107], v[24:27]
buffer_load_dwordx4 v248, s[8:11], s95 offen offset:0  lds
v_and_b32 v225, s97, v226
v_mfma_f32_16x16x32_bf16 v[64:67], v[140:143], v[104:107], v[64:67]
ds_read_b128 v[104:107], v169 offset:4096
v_add_f32 v229, v229, v224
v_mfma_f32_16x16x32_bf16 v[28:31], v[136:139], v[108:111], v[28:31]
v_add_f32 v230, v230, v225
v_mfma_f32_16x16x32_bf16 v[68:71], v[140:143], v[108:111], v[68:71]
ds_read_b128 v[108:111], v169 offset:6144
v_mfma_f32_16x16x32_bf16 v[32:35], v[136:139], v[112:115], v[32:35]
buffer_load_dwordx4 v249, s[8:11], s95 offen offset:1024  lds
v_mfma_f32_16x16x32_bf16 v[72:75], v[140:143], v[112:115], v[72:75]
ds_read_b128 v[112:115], v169 offset:8192
s_waitcnt lgkmcnt(4)
v_mfma_f32_16x16x32_bf16 v[36:39], v[136:139], v[116:119], v[36:39]
v_mfma_f32_16x16x32_bf16 v[76:79], v[140:143], v[116:119], v[76:79]
ds_read_b128 v[116:119], v169 offset:10240
v_mfma_f32_16x16x32_bf16 v[40:43], v[136:139], v[120:123], v[40:43]
buffer_load_dwordx4 v250, s[8:11], s95 offen offset:2048  lds
v_mfma_f32_16x16x32_bf16 v[80:83], v[140:143], v[120:123], v[80:83]
ds_read_b128 v[120:123], v169 offset:12288
v_mfma_f32_16x16x32_bf16 v[44:47], v[136:139], v[124:127], v[44:47]
v_mfma_f32_16x16x32_bf16 v[84:87], v[140:143], v[124:127], v[84:87]
ds_read_b128 v[124:127], v169 offset:14336
v_mfma_f32_16x16x32_bf16 v[48:51], v[136:139], v[128:131], v[48:51]
buffer_load_dwordx4 v251, s[8:11], s95 offen offset:3072  lds
v_mfma_f32_16x16x32_bf16 v[88:91], v[140:143], v[128:131], v[88:91]
ds_read_b128 v[128:131], v169 offset:16384
v_mfma_f32_16x16x32_bf16 v[52:55], v[136:139], v[132:135], v[52:55]
v_mfma_f32_16x16x32_bf16 v[92:95], v[140:143], v[132:135], v[92:95]
ds_read_b128 v[132:135], v169 offset:18432
v_mfma_f32_16x16x32_bf16 v[16:19], v[144:147], v[96:99], v[16:19]
s_add_u32 m0, s93, 4096
v_mfma_f32_16x16x32_bf16 v[56:59], v[148:151], v[96:99], v[56:59]
buffer_load_dwordx4 v252, s[8:11], s95 offen offset:0  lds
s_waitcnt lgkmcnt(3)
v_mfma_f32_16x16x32_bf16 v[20:23], v[144:147], v[100:103], v[20:23]
s_add_u32 s95, s95, 128
s_cmp_eq_u32 s95, 1280
s_cselect_b32 s95, 0, s95
v_mfma_f32_16x16x32_bf16 v[60:63], v[148:151], v[100:103], v[60:63]
v_mfma_f32_16x16x32_bf16 v[24:27], v[144:147], v[104:107], v[24:27]
v_mfma_f32_16x16x32_bf16 v[64:67], v[148:151], v[104:107], v[64:67]
s_waitcnt vmcnt(20) lgkmcnt(0)
s_barrier
v_mfma_f32_16x16x32_bf16 v[28:31], v[144:147], v[108:111], v[28:31]
ds_read_b128 v[136:139], v158 offset:0
s_add_u32 m0, s92, 40960
L_tag:
v_cmp_eq_u32 vcc, 1, v15
v_mov_b32 v186, v14
s_cbranch_vccz L_tag_slow
L_tag_ok:
v_mfma_f32_16x16x32_bf16 v[68:71], v[148:151], v[108:111], v[68:71]
ds_read_b128 v[96:99], v166 offset:0
buffer_load_dwordx4 v172, s[4:7], s95 offen offset:0  lds
v_mfma_f32_16x16x32_bf16 v[32:35], v[144:147], v[112:115], v[32:35]
ds_read_b128 v[140:143], v158 offset:2048
v_xor_b32 v187, 0x9e3779b9, v14
v_mfma_f32_16x16x32_bf16 v[72:75], v[148:151], v[112:115], v[72:75]
ds_read_b128 v[100:103], v166 offset:2048
v_mfma_f32_16x16x32_bf16 v[36:39], v[144:147], v[116:119], v[36:39]
ds_read_b128 v[104:107], v166 offset:4096
buffer_store_dwordx2 v[186:187], v198, s[16:19], s53 offen sc1
v_mfma_f32_16x16x32_bf16 v[76:79], v[148:151], v[116:119], v[76:79]
ds_read_b128 v[108:111], v166 offset:6144
buffer_load_dwordx4 v173, s[4:7], s95 offen offset:1024  lds
v_mfma_f32_16x16x32_bf16 v[40:43], v[144:147], v[120:123], v[40:43]
ds_read_b128 v[112:115], v166 offset:8192
v_lshlrev_b32 v224, 16, v204
v_mfma_f32_16x16x32_bf16 v[80:83], v[148:151], v[120:123], v[80:83]
ds_read_b128 v[116:119], v166 offset:10240
v_and_b32 v225, s97, v204
v_mfma_f32_16x16x32_bf16 v[44:47], v[144:147], v[124:127], v[44:47]
ds_read_b128 v[120:123], v166 offset:12288
v_lshlrev_b32 v226, 16, v216
v_mfma_f32_16x16x32_bf16 v[84:87], v[148:151], v[124:127], v[84:87]
ds_read_b128 v[124:127], v166 offset:14336
buffer_load_dwordx4 v174, s[4:7], s95 offen offset:2048  lds
v_mfma_f32_16x16x32_bf16 v[48:51], v[144:147], v[128:131], v[48:51]
v_and_b32 v227, s97, v216
v_mfma_f32_16x16x32_bf16 v[88:91], v[148:151], v[128:131], v[88:91]
ds_read_b128 v[128:131], v166 offset:16384
v_mul_f32 v224, v224, v226
v_mfma_f32_16x16x32_bf16 v[52:55], v[144:147], v[132:135], v[52:55]
v_mul_f32 v225, v225, v227
v_mfma_f32_16x16x32_bf16 v[92:95], v[148:151], v[132:135], v[92:95]
ds_read_b128 v[132:135], v166 offset:18432
buffer_load_dwordx4 v175, s[4:7], s95 offen offset:3072  lds
s_waitcnt lgkmcnt(5)
v_mfma_f32_16x16x32_bf16 v[16:19], v[136:139], v[96:99], v[16:19]
ds_read_b128 v[144:147], v162 offset:0
v_cvt_pk_bf16_f32 v226, v224, v225
v_mfma_f32_16x16x32_bf16 v[56:59], v[140:143], v[96:99], v[56:59]
ds_read_b128 v[96:99], v170 offset:0
v_lshlrev_b32 v224, 16, v226
v_mfma_f32_16x16x32_bf16 v[20:23], v[136:139], v[100:103], v[20:23]
ds_read_b128 v[148:151], v162 offset:2048
v_and_b32 v225, s97, v226
v_mfma_f32_16x16x32_bf16 v[60:63], v[140:143], v[100:103], v[60:63]
ds_read_b128 v[100:103], v170 offset:2048
s_add_u32 m0, s93, 40960
v_mfma_f32_16x16x32_bf16 v[24:27], v[136:139], v[104:107], v[24:27]
buffer_load_dwordx4 v248, s[8:11], s95 offen offset:0  lds
v_add_f32 v229, v229, v224
v_mfma_f32_16x16x32_bf16 v[64:67], v[140:143], v[104:107], v[64:67]
ds_read_b128 v[104:107], v170 offset:4096
v_add_f32 v230, v230, v225
v_mfma_f32_16x16x32_bf16 v[28:31], v[136:139], v[108:111], v[28:31]
v_lshlrev_b32 v224, 16, v205
v_mfma_f32_16x16x32_bf16 v[68:71], v[140:143], v[108:111], v[68:71]
ds_read_b128 v[108:111], v170 offset:6144
v_and_b32 v225, s97, v205
v_mfma_f32_16x16x32_bf16 v[32:35], v[136:139], v[112:115], v[32:35]
buffer_load_dwordx4 v249, s[8:11], s95 offen offset:1024  lds
v_lshlrev_b32 v226, 16, v217
v_mfma_f32_16x16x32_bf16 v[72:75], v[140:143], v[112:115], v[72:75]
ds_read_b128 v[112:115], v170 offset:8192
s_waitcnt lgkmcnt(4)
v_mfma_f32_16x16x32_bf16 v[36:39], v[136:139], v[116:119], v[36:39]
v_and_b32 v227, s97, v217
v_mfma_f32_16x16x32_bf16 v[76:79], v[140:143], v[116:119], v[76:79]
ds_read_b128 v[116:119], v170 offset:10240
v_mul_f32 v224, v224, v226
v_mfma_f32_16x16x32_bf16 v[40:43], v[136:139], v[120:123], v[40:43]
buffer_load_dwordx4 v250, s[8:11], s95 offen offset:2048  lds
v_mul_f32 v225, v225, v227
v_mfma_f32_16x16x32_bf16 v[80:83], v[140:143], v[120:123], v[80:83]
ds_read_b128 v[120:123], v170 offset:12288
v_cvt_pk_bf16_f32 v226, v224, v225
v_mfma_f32_16x16x32_bf16 v[44:47], v[136:139], v[124:127], v[44:47]
v_lshlrev_b32 v224, 16, v226
v_mfma_f32_16x16x32_bf16 v[84:87], v[140:143], v[124:127], v[84:87]
ds_read_b128 v[124:127], v170 offset:14336
v_and_b32 v225, s97, v226
v_mfma_f32_16x16x32_bf16 v[48:51], v[136:139], v[128:131], v[48:51]
buffer_load_dwordx4 v251, s[8:11], s95 offen offset:3072  lds
v_add_f32 v229, v229, v224
v_mfma_f32_16x16x32_bf16 v[88:91], v[140:143], v[128:131], v[88:91]
ds_read_b128 v[128:131], v170 offset:16384
v_add_f32 v230, v230, v225
v_mfma_f32_16x16x32_bf16 v[52:55], v[136:139], v[132:135], v[52:55]
v_lshlrev_b32 v224, 16, v206
v_mfma_f32_16x16x32_bf16 v[92:95], v[140:143], v[132:135], v[92:95]
ds_read_b128 v[132:135], v170 offset:18432
v_and_b32 v225, s97, v206
v_mfma_f32_16x16x32_bf16 v[16:19], v[144:147], v[96:99], v[16:19]
s_add_u32 m0, s93, 45056
v_lshlrev_b32 v226, 16, v218
v_mfma_f32_16x16x32_bf16 v[56:59], v[148:151], v[96:99], v[56:59]
buffer_load_dwordx4 v252, s[8:11], s95 offen offset:0  lds
s_waitcnt lgkmcnt(3)
v_mfma_f32_16x16x32_bf16 v[20:23], v[144:147], v[100:103], v[20:23]
s_add_u32 s95, s95, 128
s_cmp_eq_u32 s95, 1280
s_cselect_b32 s95, 0, s95
v_mfma_f32_16x16x32_bf16 v[60:63], v[148:151], v[100:103], v[60:63]
v_and_b32 v227, s97, v218
v_mfma_f32_16x16x32_bf16 v[24:27], v[144:147], v[104:107], v[24:27]
v_mul_f32 v224, v224, v226
v_mfma_f32_16x16x32_bf16 v[64:67], v[148:151], v[104:107], v[64:67]
s_waitcnt vmcnt(19) lgkmcnt(0)
s_barrier
v_mfma_f32_16x16x32_bf16 v[28:31], v[144:147], v[108:111], v[28:31]
ds_read_b128 v[136:139], v159 offset:0
s_add_u32 m0, s94, 81920
v_mfma_f32_16x16x32_bf16 v[68:71], v[148:151], v[108:111], v[68:71]
ds_read_b128 v[96:99], v167 offset:0
buffer_load_dwordx4 v238, s[12:15], s96 offen offset:0  lds
v_mfma_f32_16x16x32_bf16 v[32:35], v[144:147], v[112:115], v[32:35]
ds_read_b128 v[140:143], v159 offset:2048
v_mul_f32 v225, v225, v227
v_mfma_f32_16x16x32_bf16 v[72:75], v[148:151], v[112:115], v[72:75]
ds_read_b128 v[100:103], v167 offset:2048
v_cvt_pk_bf16_f32 v226, v224, v225
v_mfma_f32_16x16x32_bf16 v[36:39], v[144:147], v[116:119], v[36:39]
ds_read_b128 v[104:107], v167 offset:4096
v_lshlrev_b32 v224, 16, v226
v_mfma_f32_16x16x32_bf16 v[76:79], v[148:151], v[116:119], v[76:79]
ds_read_b128 v[108:111], v167 offset:6144
v_and_b32 v225, s97, v226
v_mfma_f32_16x16x32_bf16 v[40:43], v[144:147], v[120:123], v[40:43]
ds_read_b128 v[112:115], v167 offset:8192
v_add_f32 v229, v229, v224
v_mfma_f32_16x16x32_bf16 v[80:83], v[148:151], v[120:123], v[80:83]
ds_read_b128 v[116:119], v167 offset:10240
v_add_f32 v230, v230, v225
v_mfma_f32_16x16x32_bf16 v[44:47], v[144:147], v[124:127], v[44:47]
ds_read_b128 v[120:123], v167 offset:12288
v_lshlrev_b32 v224, 16, v207
v_mfma_f32_16x16x32_bf16 v[84:87], v[148:151], v[124:127], v[84:87]
ds_read_b128 v[124:127], v167 offset:14336
v_and_b32 v225, s97, v207
v_mfma_f32_16x16x32_bf16 v[48:51], v[144:147], v[128:131], v[48:51]
v_lshlrev_b32 v226, 16, v219
v_mfma_f32_16x16x32_bf16 v[88:91], v[148:151], v[128:131], v[88:91]
ds_read_b128 v[128:131], v167 offset:16384
v_and_b32 v227, s97, v219
v_mfma_f32_16x16x32_bf16 v[52:55], v[144:147], v[132:135], v[52:55]
buffer_load_dwordx4 v239, s[12:15], s96 offen offset:1024  lds
v_mul_f32 v224, v224, v226
v_mfma_f32_16x16x32_bf16 v[92:95], v[148:151], v[132:135], v[92:95]
ds_read_b128 v[132:135], v167 offset:18432
s_waitcnt lgkmcnt(5)
v_mfma_f32_16x16x32_bf16 v[16:19], v[136:139], v[96:99], v[16:19]
ds_read_b128 v[144:147], v163 offset:0
v_mul_f32 v225, v225, v227
v_mfma_f32_16x16x32_bf16 v[56:59], v[140:143], v[96:99], v[56:59]
ds_read_b128 v[96:99], v171 offset:0
v_cvt_pk_bf16_f32 v226, v224, v225
v_mfma_f32_16x16x32_bf16 v[20:23], v[136:139], v[100:103], v[20:23]
ds_read_b128 v[148:151], v163 offset:2048
v_lshlrev_b32 v224, 16, v226
v_mfma_f32_16x16x32_bf16 v[60:63], v[140:143], v[100:103], v[60:63]
ds_read_b128 v[100:103], v171 offset:2048
v_and_b32 v225, s97, v226
v_mfma_f32_16x16x32_bf16 v[24:27], v[136:139], v[104:107], v[24:27]
v_add_f32 v229, v229, v224
v_mfma_f32_16x16x32_bf16 v[64:67], v[140:143], v[104:107], v[64:67]
ds_read_b128 v[104:107], v171 offset:4096
v_add_f32 v230, v230, v225
v_mfma_f32_16x16x32_bf16 v[28:31], v[136:139], v[108:111], v[28:31]
v_lshlrev_b32 v224, 16, v208
v_mfma_f32_16x16x32_bf16 v[68:71], v[140:143], v[108:111], v[68:71]
ds_read_b128 v[108:111], v171 offset:6144
v_and_b32 v225, s97, v208
v_mfma_f32_16x16x32_bf16 v[32:35], v[136:139], v[112:115], v[32:35]
v_lshlrev_b32 v226, 16, v220
v_mfma_f32_16x16x32_bf16 v[72:75], v[140:143], v[112:115], v[72:75]
ds_read_b128 v[112:115], v171 offset:8192
buffer_load_dwordx4 v240, s[12:15], s96 offen offset:2048  lds
s_waitcnt lgkmcnt(4)
v_mfma_f32_16x16x32_bf16 v[36:39], v[136:139], v[116:119], v[36:39]
v_and_b32 v227, s97, v220
v_mfma_f32_16x16x32_bf16 v[76:79], v[140:143], v[116:119], v[76:79]
ds_read_b128 v[116:119], v171 offset:10240
v_mul_f32 v224, v224, v226
v_mfma_f32_16x16x32_bf16 v[40:43], v[136:139], v[120:123], v[40:43]
v_mul_f32 v225, v225, v227
v_mfma_f32_16x16x32_bf16 v[80:83], v[140:143], v[120:123], v[80:83]
ds_read_b128 v[120:123], v171 offset:12288
v_cvt_pk_bf16_f32 v226, v224, v225
v_mfma_f32_16x16x32_bf16 v[44:47], v[136:139], v[124:127], v[44:47]
v_lshlrev_b32 v224, 16, v226
v_mfma_f32_16x16x32_bf16 v[84:87], v[140:143], v[124:127], v[84:87]
ds_read_b128 v[124:127], v171 offset:14336
v_and_b32 v225, s97, v226
v_mfma_f32_16x16x32_bf16 v[48:51], v[136:139], v[128:131], v[48:51]
v_add_f32 v229, v229, v224
v_mfma_f32_16x16x32_bf16 v[88:91], v[140:143], v[128:131], v[88:91]
ds_read_b128 v[128:131], v171 offset:16384
v_add_f32 v230, v230, v225
v_mfma_f32_16x16x32_bf16 v[52:55], v[136:139], v[132:135], v[52:55]
v_lshlrev_b32 v224, 16, v209
v_mfma_f32_16x16x32_bf16 v[92:95], v[140:143], v[132:135], v[92:95]
ds_read_b128 v[132:135], v171 offset:18432
v_and_b32 v225, s97, v209
v_mfma_f32_16x16x32_bf16 v[16:19], v[144:147], v[96:99], v[16:19]
buffer_load_dwordx4 v241, s[12:15], s96 offen offset:3072  lds
v_lshlrev_b32 v226, 16, v221
v_mfma_f32_16x16x32_bf16 v[56:59], v[148:151], v[96:99], v[56:59]
v_and_b32 v227, s97, v221
s_waitcnt lgkmcnt(3)
v_mfma_f32_16x16x32_bf16 v[20:23], v[144:147], v[100:103], v[20:23]
v_mul_f32 v224, v224, v226
v_mfma_f32_16x16x32_bf16 v[60:63], v[148:151], v[100:103], v[60:63]
v_mul_f32 v225, v225, v227
v_mfma_f32_16x16x32_bf16 v[24:27], v[144:147], v[104:107], v[24:27]
v_cvt_pk_bf16_f32 v226, v224, v225
v_mfma_f32_16x16x32_bf16 v[64:67], v[148:151], v[104:107], v[64:67]
s_waitcnt vmcnt(14) lgkmcnt(0)
s_barrier
v_mfma_f32_16x16x32_bf16 v[28:31], v[144:147], v[108:111], v[28:31]
ds_read_b128 v[136:139], v156 offset:0
v_lshlrev_b32 v224, 16, v226
v_mfma_f32_16x16x32_bf16 v[68:71], v[148:151], v[108:111], v[68:71]
ds_read_b128 v[96:99], v164 offset:0
v_and_b32 v225, s97, v226
v_mfma_f32_16x16x32_bf16 v[32:35], v[144:147], v[112:115], v[32:35]
ds_read_b128 v[140:143], v156 offset:2048
v_add_f32 v229, v229, v224
v_mfma_f32_16x16x32_bf16 v[72:75], v[148:151], v[112:115], v[72:75]
ds_read_b128 v[100:103], v164 offset:2048
v_add_f32 v230, v230, v225
v_mfma_f32_16x16x32_bf16 v[36:39], v[144:147], v[116:119], v[36:39]
ds_read_b128 v[104:107], v164 offset:4096
s_add_u32 m0, s94, 86016
v_mfma_f32_16x16x32_bf16 v[76:79], v[148:151], v[116:119], v[76:79]
ds_read_b128 v[108:111], v164 offset:6144
buffer_load_dwordx4 v242, s[12:15], s96 offen offset:0  lds
v_mfma_f32_16x16x32_bf16 v[40:43], v[144:147], v[120:123], v[40:43]
ds_read_b128 v[112:115], v164 offset:8192
v_lshlrev_b32 v224, 16, v210
v_mfma_f32_16x16x32_bf16 v[80:83], v[148:151], v[120:123], v[80:83]
ds_read_b128 v[116:119], v164 offset:10240
v_and_b32 v225, s97, v210
v_mfma_f32_16x16x32_bf16 v[44:47], v[144:147], v[124:127], v[44:47]
ds_read_b128 v[120:123], v164 offset:12288
v_lshlrev_b32 v226, 16, v222
v_mfma_f32_16x16x32_bf16 v[84:87], v[148:151], v[124:127], v[84:87]
ds_read_b128 v[124:127], v164 offset:14336
v_and_b32 v227, s97, v222
v_mfma_f32_16x16x32_bf16 v[48:51], v[144:147], v[128:131], v[48:51]
v_mul_f32 v224, v224, v226
v_mfma_f32_16x16x32_bf16 v[88:91], v[148:151], v[128:131], v[88:91]
ds_read_b128 v[128:131], v164 offset:16384
v_mul_f32 v225, v225, v227
v_mfma_f32_16x16x32_bf16 v[52:55], v[144:147], v[132:135], v[52:55]
v_cvt_pk_bf16_f32 v226, v224, v225
v_mfma_f32_16x16x32_bf16 v[92:95], v[148:151], v[132:135], v[92:95]
ds_read_b128 v[132:135], v164 offset:18432
s_waitcnt lgkmcnt(5)
v_mfma_f32_16x16x32_bf16 v[16:19], v[136:139], v[96:99], v[16:19]
ds_read_b128 v[144:147], v160 offset:0
v_lshlrev_b32 v224, 16, v226
v_mfma_f32_16x16x32_bf16 v[56:59], v[140:143], v[96:99], v[56:59]
ds_read_b128 v[96:99], v168 offset:0
v_and_b32 v225, s97, v226
v_mfma_f32_16x16x32_bf16 v[20:23], v[136:139], v[100:103], v[20:23]
ds_read_b128 v[148:151], v160 offset:2048
buffer_load_dwordx4 v243, s[12:15], s96 offen offset:1024  lds
v_mfma_f32_16x16x32_bf16 v[60:63], v[140:143], v[100:103], v[60:63]
ds_read_b128 v[100:103], v168 offset:2048
v_add_f32 v229, v229, v224
v_mfma_f32_16x16x32_bf16 v[24:27], v[136:139], v[104:107], v[24:27]
v_add_f32 v230, v230, v225
v_mfma_f32_16x16x32_bf16 v[64:67], v[140:143], v[104:107], v[64:67]
ds_read_b128 v[104:107], v168 offset:4096
v_lshlrev_b32 v224, 16, v211
v_mfma_f32_16x16x32_bf16 v[28:31], v[136:139], v[108:111], v[28:31]
v_and_b32 v225, s97, v211
v_mfma_f32_16x16x32_bf16 v[68:71], v[140:143], v[108:111], v[68:71]
ds_read_b128 v[108:111], v168 offset:6144
v_lshlrev_b32 v226, 16, v223
v_mfma_f32_16x16x32_bf16 v[32:35], v[136:139], v[112:115], v[32:35]
v_and_b32 v227, s97, v223
v_mfma_f32_16x16x32_bf16 v[72:75], v[140:143], v[112:115], v[72:75]
ds_read_b128 v[112:115], v168 offset:8192
s_waitcnt lgkmcnt(4)
v_mfma_f32_16x16x32_bf16 v[36:39], v[136:139], v[116:119], v[36:39]
v_mul_f32 v224, v224, v226
v_mfma_f32_16x16x32_bf16 v[76:79], v[140:143], v[116:119], v[76:79]
ds_read_b128 v[116:119], v168 offset:10240
v_mul_f32 v225, v225, v227
v_mfma_f32_16x16x32_bf16 v[40:43], v[136:139], v[120:123], v[40:43]
v_cvt_pk_bf16_f32 v226, v224, v225
v_mfma_f32_16x16x32_bf16 v[80:83], v[140:143], v[120:123], v[80:83]
ds_read_b128 v[120:123], v168 offset:12288
buffer_load_dwordx4 v244, s[12:15], s96 offen offset:2048  lds
v_mfma_f32_16x16x32_bf16 v[44:47], v[136:139], v[124:127], v[44:47]
v_lshlrev_b32 v224, 16, v226
v_mfma_f32_16x16x32_bf16 v[84:87], v[140:143], v[124:127], v[84:87]
ds_read_b128 v[124:127], v168 offset:14336
v_and_b32 v225, s97, v226
v_mfma_f32_16x16x32_bf16 v[48:51], v[136:139], v[128:131], v[48:51]
v_add_f32 v229, v229, v224
v_mfma_f32_16x16x32_bf16 v[88:91], v[140:143], v[128:131], v[88:91]
ds_read_b128 v[128:131], v168 offset:16384
v_add_f32 v230, v230, v225
v_mfma_f32_16x16x32_bf16 v[52:55], v[136:139], v[132:135], v[52:55]
v_add_f32 v224, v229, v230
v_mfma_f32_16x16x32_bf16 v[92:95], v[140:143], v[132:135], v[92:95]
ds_read_b128 v[132:135], v168 offset:18432
v_mfma_f32_16x16x32_bf16 v[16:19], v[144:147], v[96:99], v[16:19]
v_add_f32_dpp v224, v224, v224 row_ror:8 row_mask:0xf bank_mask:0xf
v_mfma_f32_16x16x32_bf16 v[56:59], v[148:151], v[96:99], v[56:59]
v_accvgpr_read_b32 v11, a214
s_waitcnt lgkmcnt(3)
v_mfma_f32_16x16x32_bf16 v[20:23], v[144:147], v[100:103], v[20:23]
v_add_f32_dpp v224, v224, v224 row_ror:4 row_mask:0xf bank_mask:0xf
v_mfma_f32_16x16x32_bf16 v[60:63], v[148:151], v[100:103], v[60:63]
buffer_load_dwordx2 v[6:7], v11, s[16:19], 0 offen sc1
v_mfma_f32_16x16x32_bf16 v[24:27], v[144:147], v[104:107], v[24:27]
buffer_load_dwordx4 v245, s[12:15], s96 offen offset:3072  lds
v_add_f32_dpp v224, v224, v224 row_ror:2 row_mask:0xf bank_mask:0xf
v_mfma_f32_16x16x32_bf16 v[64:67], v[148:151], v[104:107], v[64:67]
s_waitcnt vmcnt(9) lgkmcnt(0)
s_barrier
v_mfma_f32_16x16x32_bf16 v[28:31], v[144:147], v[108:111], v[28:31]
ds_read_b128 v[136:139], v157 offset:0
v_add_f32_dpp v224, v224, v224 row_ror:1 row_mask:0xf bank_mask:0xf
v_mfma_f32_16x16x32_bf16 v[68:71], v[148:151], v[108:111], v[68:71]
ds_read_b128 v[96:99], v165 offset:0
v_mov_b32 v225, v224
v_mfma_f32_16x16x32_bf16 v[32:35], v[144:147], v[112:115], v[32:35]
ds_read_b128 v[140:143], v157 offset:2048
v_mfma_f32_16x16x32_bf16 v[72:75], v[148:151], v[112:115], v[72:75]
ds_read_b128 v[100:103], v165 offset:2048
v_permlane16_swap_b32 v224, v225
v_mfma_f32_16x16x32_bf16 v[36:39], v[144:147], v[116:119], v[36:39]
ds_read_b128 v[104:107], v165 offset:4096
v_add_f32 v224, v224, v225
v_mfma_f32_16x16x32_bf16 v[76:79], v[148:151], v[116:119], v[76:79]
ds_read_b128 v[108:111], v165 offset:6144
v_cvt_pk_bf16_f32 v224, v224, v224
v_mfma_f32_16x16x32_bf16 v[40:43], v[144:147], v[120:123], v[40:43]
ds_read_b128 v[112:115], v165 offset:8192
v_lshlrev_b32 v224, 16, v224
v_mfma_f32_16x16x32_bf16 v[80:83], v[148:151], v[120:123], v[80:83]
ds_read_b128 v[116:119], v165 offset:10240
v_mul_f32 v224, 0xbfb8aa3b, v224
v_mfma_f32_16x16x32_bf16 v[44:47], v[144:147], v[124:127], v[44:47]
ds_read_b128 v[120:123], v165 offset:12288
s_add_u32 m0, s94, 90112
v_mfma_f32_16x16x32_bf16 v[84:87], v[148:151], v[124:127], v[84:87]
ds_read_b128 v[124:127], v165 offset:14336
buffer_load_dwordx4 v246, s[12:15], s96 offen offset:0  lds
v_mfma_f32_16x16x32_bf16 v[48:51], v[144:147], v[128:131], v[48:51]
v_exp_f32 v224, v224
v_mfma_f32_16x16x32_bf16 v[88:91], v[148:151], v[128:131], v[88:91]
ds_read_b128 v[128:131], v165 offset:16384
v_add_f32 v224, 1.0, v224
v_mfma_f32_16x16x32_bf16 v[52:55], v[144:147], v[132:135], v[52:55]
v_rcp_f32 v224, v224
v_mfma_f32_16x16x32_bf16 v[92:95], v[148:151], v[132:135], v[92:95]
ds_read_b128 v[132:135], v165 offset:18432
s_waitcnt lgkmcnt(5)
v_mfma_f32_16x16x32_bf16 v[16:19], v[136:139], v[96:99], v[16:19]
ds_read_b128 v[144:147], v161 offset:0
v_cvt_pk_bf16_f32 v224, v224, v224
v_mfma_f32_16x16x32_bf16 v[56:59], v[140:143], v[96:99], v[56:59]
ds_read_b128 v[96:99], v169 offset:0
v_lshlrev_b32 v228, 16, v224
v_mfma_f32_16x16x32_bf16 v[20:23], v[136:139], v[100:103], v[20:23]
ds_read_b128 v[148:151], v161 offset:2048
v_sub_f32 v224, 1.0, v228
v_mfma_f32_16x16x32_bf16 v[60:63], v[140:143], v[100:103], v[60:63]
ds_read_b128 v[100:103], v169 offset:2048
v_cvt_pk_bf16_f32 v224, v224, v224
v_mfma_f32_16x16x32_bf16 v[24:27], v[136:139], v[104:107], v[24:27]
v_lshlrev_b32 v229, 16, v224
v_mfma_f32_16x16x32_bf16 v[64:67], v[140:143], v[104:107], v[64:67]
ds_read_b128 v[104:107], v169 offset:4096
v_mov_b32 v230, v186
v_mfma_f32_16x16x32_bf16 v[28:31], v[136:139], v[108:111], v[28:31]
v_mov_b32 v231, v187
v_mfma_f32_16x16x32_bf16 v[68:71], v[140:143], v[108:111], v[68:71]
ds_read_b128 v[108:111], v169 offset:6144
buffer_load_dwordx4 v247, s[12:15], s96 offen offset:1024  lds
v_mfma_f32_16x16x32_bf16 v[32:35], v[136:139], v[112:115], v[32:35]
s_add_u32 s96, s96, 128
s_cmp_eq_u32 s96, 640
s_cselect_b32 s96, 0, s96
v_mfma_f32_16x16x32_bf16 v[72:75], v[140:143], v[112:115], v[72:75]
ds_read_b128 v[112:115], v169 offset:8192
s_waitcnt lgkmcnt(4)
v_mfma_f32_16x16x32_bf16 v[36:39], v[136:139], v[116:119], v[36:39]
buffer_store_dwordx4 v[228:231], v197, s[16:19], 0 offen sc1
v_mfma_f32_16x16x32_bf16 v[76:79], v[140:143], v[116:119], v[76:79]
ds_read_b128 v[116:119], v169 offset:10240
v_mfma_f32_16x16x32_bf16 v[40:43], v[136:139], v[120:123], v[40:43]
v_mfma_f32_16x16x32_bf16 v[80:83], v[140:143], v[120:123], v[80:83]
ds_read_b128 v[120:123], v169 offset:12288
v_mfma_f32_16x16x32_bf16 v[44:47], v[136:139], v[124:127], v[44:47]
v_mfma_f32_16x16x32_bf16 v[84:87], v[140:143], v[124:127], v[84:87]
ds_read_b128 v[124:127], v169 offset:14336
v_mfma_f32_16x16x32_bf16 v[48:51], v[136:139], v[128:131], v[48:51]
v_mfma_f32_16x16x32_bf16 v[88:91], v[140:143], v[128:131], v[88:91]
ds_read_b128 v[128:131], v169 offset:16384
v_mfma_f32_16x16x32_bf16 v[52:55], v[136:139], v[132:135], v[52:55]
v_mfma_f32_16x16x32_bf16 v[92:95], v[140:143], v[132:135], v[92:95]
ds_read_b128 v[132:135], v169 offset:18432
v_mfma_f32_16x16x32_bf16 v[16:19], v[144:147], v[96:99], v[16:19]
v_mfma_f32_16x16x32_bf16 v[56:59], v[148:151], v[96:99], v[56:59]
s_waitcnt lgkmcnt(3)
v_mfma_f32_16x16x32_bf16 v[20:23], v[144:147], v[100:103], v[20:23]
v_mfma_f32_16x16x32_bf16 v[60:63], v[148:151], v[100:103], v[60:63]
v_mfma_f32_16x16x32_bf16 v[24:27], v[144:147], v[104:107], v[24:27]
v_mfma_f32_16x16x32_bf16 v[64:67], v[148:151], v[104:107], v[64:67]
s_waitcnt lgkmcnt(0)
s_barrier
v_mfma_f32_16x16x32_bf16 v[28:31], v[144:147], v[108:111], v[28:31]
ds_read_b128 v[200:203], v9 offset:0
v_mfma_f32_16x16x32_bf16 v[68:71], v[148:151], v[108:111], v[68:71]
ds_read_b64 v[220:221], v9 offset:16
v_mfma_f32_16x16x32_bf16 v[32:35], v[144:147], v[112:115], v[32:35]
ds_read_b128 v[204:207], v9 offset:512
v_mfma_f32_16x16x32_bf16 v[72:75], v[148:151], v[112:115], v[72:75]
ds_read_b64 v[222:223], v9 offset:528
v_mfma_f32_16x16x32_bf16 v[36:39], v[144:147], v[116:119], v[36:39]
ds_read_b128 v[208:211], v9 offset:1024
v_mfma_f32_16x16x32_bf16 v[76:79], v[148:151], v[116:119], v[76:79]
ds_read_b64 v[224:225], v9 offset:1040
v_mfma_f32_16x16x32_bf16 v[40:43], v[144:147], v[120:123], v[40:43]
ds_read_b128 v[212:215], v9 offset:1536
v_mfma_f32_16x16x32_bf16 v[80:83], v[148:151], v[120:123], v[80:83]
ds_read_b64 v[226:227], v9 offset:1552
v_mfma_f32_16x16x32_bf16 v[44:47], v[144:147], v[124:127], v[44:47]
ds_read_b128 v[216:219], v9 offset:2048
v_mfma_f32_16x16x32_bf16 v[84:87], v[148:151], v[124:127], v[84:87]
ds_read_b64 v[228:229], v9 offset:2064
v_mfma_f32_16x16x32_bf16 v[48:51], v[144:147], v[128:131], v[48:51]
v_mfma_f32_16x16x32_bf16 v[88:91], v[148:151], v[128:131], v[88:91]
v_mfma_f32_16x16x32_bf16 v[52:55], v[144:147], v[132:135], v[52:55]
v_mfma_f32_16x16x32_bf16 v[92:95], v[148:151], v[132:135], v[92:95]
s_waitcnt lgkmcnt(9)
.p2align 3
v_pk_fma_f32 v[96:97], v[200:201], v[16:17], v[18:19] op_sel_hi:[0,1,1]
v_pk_fma_f32 v[98:99], v[200:201], v[36:37], v[38:39] op_sel_hi:[0,1,1]
v_pk_fma_f32 v[96:97], v[200:201], v[36:37], v[96:97] op_sel:[1,0,0] op_sel_hi:[1,1,1] neg_lo:[1,0,0] neg_hi:[1,0,0]
v_pk_fma_f32 v[98:99], v[200:201], v[16:17], v[98:99] op_sel:[1,0,0] op_sel_hi:[1,1,1]
v_pk_fma_f32 v[116:117], v[200:201], v[96:97], v[56:57] op_sel_hi:[0,1,1]
v_pk_fma_f32 v[118:119], v[200:201], v[98:99], v[76:77] op_sel_hi:[0,1,1]
v_pk_fma_f32 v[116:117], v[200:201], v[98:99], v[116:117] op_sel:[1,0,0] op_sel_hi:[1,1,1] neg_lo:[1,0,0] neg_hi:[1,0,0]
v_pk_fma_f32 v[118:119], v[200:201], v[96:97], v[118:119] op_sel:[1,0,0] op_sel_hi:[1,1,1]
v_pk_fma_f32 v[96:97], v[200:201], v[116:117], v[58:59] op_sel_hi:[0,1,1]
v_pk_fma_f32 v[98:99], v[200:201], v[118:119], v[78:79] op_sel_hi:[0,1,1]
v_pk_fma_f32 v[96:97], v[200:201], v[118:119], v[96:97] op_sel:[1,0,0] op_sel_hi:[1,1,1] neg_lo:[1,0,0] neg_hi:[1,0,0]
v_pk_fma_f32 v[98:99], v[200:201], v[116:117], v[98:99] op_sel:[1,0,0] op_sel_hi:[1,1,1]
v_fma_f32 v120, v202, v96, v97
v_fma_f32 v121, v202, v98, v99
v_fma_f32 v120, -v203, v98, v120
v_fma_f32 v121, v203, v96, v121
ds_write_b64 v12, v[120:121] offset:0
s_waitcnt lgkmcnt(1)
v_pk_fma_f32 v[100:101], v[204:205], v[20:21], v[22:23] op_sel_hi:[0,1,1]
v_pk_fma_f32 v[102:103], v[204:205], v[40:41], v[42:43] op_sel_hi:[0,1,1]
v_pk_fma_f32 v[100:101], v[204:205], v[40:41], v[100:101] op_sel:[1,0,0] op_sel_hi:[1,1,1] neg_lo:[1,0,0] neg_hi:[1,0,0]
v_pk_fma_f32 v[102:103], v[204:205], v[20:21], v[102:103] op_sel:[1,0,0] op_sel_hi:[1,1,1]
v_pk_fma_f32 v[116:117], v[204:205], v[100:101], v[60:61] op_sel_hi:[0,1,1]
v_pk_fma_f32 v[118:119], v[204:205], v[102:103], v[80:81] op_sel_hi:[0,1,1]
v_pk_fma_f32 v[116:117], v[204:205], v[102:103], v[116:117] op_sel:[1,0,0] op_sel_hi:[1,1,1] neg_lo:[1,0,0] neg_hi:[1,0,0]
v_pk_fma_f32 v[118:119], v[204:205], v[100:101], v[118:119] op_sel:[1,0,0] op_sel_hi:[1,1,1]
v_pk_fma_f32 v[100:101], v[204:205], v[116:117], v[62:63] op_sel_hi:[0,1,1]
v_pk_fma_f32 v[102:103], v[204:205], v[118:119], v[82:83] op_sel_hi:[0,1,1]
v_pk_fma_f32 v[100:101], v[204:205], v[118:119], v[100:101] op_sel:[1,0,0] op_sel_hi:[1,1,1] neg_lo:[1,0,0] neg_hi:[1,0,0]
v_pk_fma_f32 v[102:103], v[204:205], v[116:117], v[102:103] op_sel:[1,0,0] op_sel_hi:[1,1,1]
v_fma_f32 v122, v206, v100, v101
v_fma_f32 v123, v206, v102, v103
v_fma_f32 v122, -v207, v102, v122
v_fma_f32 v123, v207, v100, v123
ds_write_b64 v12, v[122:123] offset:2304
v_pk_fma_f32 v[104:105], v[208:209], v[24:25], v[26:27] op_sel_hi:[0,1,1]
v_pk_fma_f32 v[106:107], v[208:209], v[44:45], v[46:47] op_sel_hi:[0,1,1]
v_pk_fma_f32 v[104:105], v[208:209], v[44:45], v[104:105] op_sel:[1,0,0] op_sel_hi:[1,1,1] neg_lo:[1,0,0] neg_hi:[1,0,0]
v_pk_fma_f32 v[106:107], v[208:209], v[24:25], v[106:107] op_sel:[1,0,0] op_sel_hi:[1,1,1]
v_pk_fma_f32 v[116:117], v[208:209], v[104:105], v[64:65] op_sel_hi:[0,1,1]
v_pk_fma_f32 v[118:119], v[208:209], v[106:107], v[84:85] op_sel_hi:[0,1,1]
v_pk_fma_f32 v[116:117], v[208:209], v[106:107], v[116:117] op_sel:[1,0,0] op_sel_hi:[1,1,1] neg_lo:[1,0,0] neg_hi:[1,0,0]
v_pk_fma_f32 v[118:119], v[208:209], v[104:105], v[118:119] op_sel:[1,0,0] op_sel_hi:[1,1,1]
v_pk_fma_f32 v[104:105], v[208:209], v[116:117], v[66:67] op_sel_hi:[0,1,1]
v_pk_fma_f32 v[106:107], v[208:209], v[118:119], v[86:87] op_sel_hi:[0,1,1]
v_pk_fma_f32 v[104:105], v[208:209], v[118:119], v[104:105] op_sel:[1,0,0] op_sel_hi:[1,1,1] neg_lo:[1,0,0] neg_hi:[1,0,0]
v_pk_fma_f32 v[106:107], v[208:209], v[116:117], v[106:107] op_sel:[1,0,0] op_sel_hi:[1,1,1]
v_fma_f32 v124, v210, v104, v105
v_fma_f32 v125, v210, v106, v107
v_fma_f32 v124, -v211, v106, v124
v_fma_f32 v125, v211, v104, v125
ds_write_b64 v12, v[124:125] offset:4608
v_pk_fma_f32 v[108:109], v[212:213], v[28:29], v[30:31] op_sel_hi:[0,1,1]
v_pk_fma_f32 v[110:111], v[212:213], v[48:49], v[50:51] op_sel_hi:[0,1,1]
v_pk_fma_f32 v[108:109], v[212:213], v[48:49], v[108:109] op_sel:[1,0,0] op_sel_hi:[1,1,1] neg_lo:[1,0,0] neg_hi:[1,0,0]
v_pk_fma_f32 v[110:111], v[212:213], v[28:29], v[110:111] op_sel:[1,0,0] op_sel_hi:[1,1,1]
v_pk_fma_f32 v[116:117], v[212:213], v[108:109], v[68:69] op_sel_hi:[0,1,1]
v_pk_fma_f32 v[118:119], v[212:213], v[110:111], v[88:89] op_sel_hi:[0,1,1]
v_pk_fma_f32 v[116:117], v[212:213], v[110:111], v[116:117] op_sel:[1,0,0] op_sel_hi:[1,1,1] neg_lo:[1,0,0] neg_hi:[1,0,0]
v_pk_fma_f32 v[118:119], v[212:213], v[108:109], v[118:119] op_sel:[1,0,0] op_sel_hi:[1,1,1]
v_pk_fma_f32 v[108:109], v[212:213], v[116:117], v[70:71] op_sel_hi:[0,1,1]
v_pk_fma_f32 v[110:111], v[212:213], v[118:119], v[90:91] op_sel_hi:[0,1,1]
v_pk_fma_f32 v[108:109], v[212:213], v[118:119], v[108:109] op_sel:[1,0,0] op_sel_hi:[1,1,1] neg_lo:[1,0,0] neg_hi:[1,0,0]
v_pk_fma_f32 v[110:111], v[212:213], v[116:117], v[110:111] op_sel:[1,0,0] op_sel_hi:[1,1,1]
v_fma_f32 v126, v214, v108, v109
v_fma_f32 v127, v214, v110, v111
v_fma_f32 v126, -v215, v110, v126
v_fma_f32 v127, v215, v108, v127
ds_write_b64 v12, v[126:127] offset:6912
v_pk_fma_f32 v[112:113], v[216:217], v[32:33], v[34:35] op_sel_hi:[0,1,1]
v_pk_fma_f32 v[114:115], v[216:217], v[52:53], v[54:55] op_sel_hi:[0,1,1]
v_pk_fma_f32 v[112:113], v[216:217], v[52:53], v[112:113] op_sel:[1,0,0] op_sel_hi:[1,1,1] neg_lo:[1,0,0] neg_hi:[1,0,0]
v_pk_fma_f32 v[114:115], v[216:217], v[32:33], v[114:115] op_sel:[1,0,0] op_sel_hi:[1,1,1]
v_pk_fma_f32 v[116:117], v[216:217], v[112:113], v[72:73] op_sel_hi:[0,1,1]
v_pk_fma_f32 v[118:119], v[216:217], v[114:115], v[92:93] op_sel_hi:[0,1,1]
v_pk_fma_f32 v[116:117], v[216:217], v[114:115], v[116:117] op_sel:[1,0,0] op_sel_hi:[1,1,1] neg_lo:[1,0,0] neg_hi:[1,0,0]
v_pk_fma_f32 v[118:119], v[216:217], v[112:113], v[118:119] op_sel:[1,0,0] op_sel_hi:[1,1,1]
v_pk_fma_f32 v[112:113], v[216:217], v[116:117], v[74:75] op_sel_hi:[0,1,1]
v_pk_fma_f32 v[114:115], v[216:217], v[118:119], v[94:95] op_sel_hi:[0,1,1]
v_pk_fma_f32 v[112:113], v[216:217], v[118:119], v[112:113] op_sel:[1,0,0] op_sel_hi:[1,1,1] neg_lo:[1,0,0] neg_hi:[1,0,0]
v_pk_fma_f32 v[114:115], v[216:217], v[116:117], v[114:115] op_sel:[1,0,0] op_sel_hi:[1,1,1]
v_fma_f32 v128, v218, v112, v113
v_fma_f32 v129, v218, v114, v115
v_fma_f32 v128, -v219, v114, v128
v_fma_f32 v129, v219, v112, v129
ds_write_b64 v12, v[128:129] offset:9216
v_mul_f32 v164, v220, v96
v_mul_f32 v165, v221, v96
v_fma_f32 v164, -v221, v98, v164
v_fma_f32 v165, -v220, v98, -v165
v_mul_f32 v166, v222, v100
v_mul_f32 v167, v223, v100
v_fma_f32 v166, -v223, v102, v166
v_fma_f32 v167, -v222, v102, -v167
s_waitcnt lgkmcnt(0)
s_barrier
s_mov_b64 exec, 0xfffff
ds_read_b128 v[132:135], v13 offset:0
ds_read_b128 v[136:139], v13 offset:16
ds_read_b128 v[140:143], v13 offset:32
ds_read_b128 v[144:147], v13 offset:48
ds_read_b128 v[148:151], v13 offset:64
ds_read_b128 v[152:155], v13 offset:80
ds_read_b128 v[156:159], v13 offset:96
ds_read_b128 v[160:163], v13 offset:112
s_mov_b64 exec, -1
v_mul_f32 v168, v224, v104
v_mul_f32 v169, v225, v104
v_fma_f32 v168, -v225, v106, v168
v_fma_f32 v169, -v224, v106, -v169
v_mul_f32 v170, v226, v108
v_mul_f32 v171, v227, v108
v_fma_f32 v170, -v227, v110, v170
v_fma_f32 v171, -v226, v110, -v171
v_mul_f32 v172, v228, v112
v_mul_f32 v173, v229, v112
v_fma_f32 v172, -v229, v114, v172
v_fma_f32 v173, -v228, v114, -v173
s_waitcnt lgkmcnt(6)
s_nop 0
v_pk_fma_f32 v[2:3], v[232:233], v[132:133], v[134:135] op_sel_hi:[0,1,1]
v_pk_fma_f32 v[2:3], v[232:233], v[132:133], v[2:3] op_sel:[1,1,0] op_sel_hi:[1,0,1] neg_lo:[0,1,0]
v_pk_fma_f32 v[4:5], v[232:233], v[2:3], v[136:137] op_sel_hi:[0,1,1]
v_pk_fma_f32 v[4:5], v[232:233], v[2:3], v[4:5] op_sel:[1,1,0] op_sel_hi:[1,0,1] neg_lo:[0,1,0]
v_pk_fma_f32 v[2:3], v[232:233], v[4:5], v[138:139] op_sel_hi:[0,1,1]
v_pk_fma_f32 v[2:3], v[232:233], v[4:5], v[2:3] op_sel:[1,1,0] op_sel_hi:[1,0,1] neg_lo:[0,1,0]
s_waitcnt lgkmcnt(4)
s_nop 0
v_pk_fma_f32 v[4:5], v[232:233], v[2:3], v[140:141] op_sel_hi:[0,1,1]
v_pk_fma_f32 v[4:5], v[232:233], v[2:3], v[4:5] op_sel:[1,1,0] op_sel_hi:[1,0,1] neg_lo:[0,1,0]
v_pk_fma_f32 v[2:3], v[232:233], v[4:5], v[142:143] op_sel_hi:[0,1,1]
v_pk_fma_f32 v[2:3], v[232:233], v[4:5], v[2:3] op_sel:[1,1,0] op_sel_hi:[1,0,1] neg_lo:[0,1,0]
v_pk_fma_f32 v[4:5], v[232:233], v[2:3], v[144:145] op_sel_hi:[0,1,1]
v_pk_fma_f32 v[4:5], v[232:233], v[2:3], v[4:5] op_sel:[1,1,0] op_sel_hi:[1,0,1] neg_lo:[0,1,0]
v_pk_fma_f32 v[2:3], v[232:233], v[4:5], v[146:147] op_sel_hi:[0,1,1]
v_pk_fma_f32 v[2:3], v[232:233], v[4:5], v[2:3] op_sel:[1,1,0] op_sel_hi:[1,0,1] neg_lo:[0,1,0]
s_waitcnt lgkmcnt(0)
s_nop 0
v_pk_fma_f32 v[4:5], v[232:233], v[2:3], v[148:149] op_sel_hi:[0,1,1]
v_pk_fma_f32 v[4:5], v[232:233], v[2:3], v[4:5] op_sel:[1,1,0] op_sel_hi:[1,0,1] neg_lo:[0,1,0]
v_pk_fma_f32 v[2:3], v[232:233], v[4:5], v[150:151] op_sel_hi:[0,1,1]
v_pk_fma_f32 v[2:3], v[232:233], v[4:5], v[2:3] op_sel:[1,1,0] op_sel_hi:[1,0,1] neg_lo:[0,1,0]
v_pk_fma_f32 v[4:5], v[232:233], v[2:3], v[152:153] op_sel_hi:[0,1,1]
v_pk_fma_f32 v[4:5], v[232:233], v[2:3], v[4:5] op_sel:[1,1,0] op_sel_hi:[1,0,1] neg_lo:[0,1,0]
v_pk_fma_f32 v[2:3], v[232:233], v[4:5], v[154:155] op_sel_hi:[0,1,1]
v_pk_fma_f32 v[2:3], v[232:233], v[4:5], v[2:3] op_sel:[1,1,0] op_sel_hi:[1,0,1] neg_lo:[0,1,0]
v_pk_fma_f32 v[4:5], v[232:233], v[2:3], v[156:157] op_sel_hi:[0,1,1]
v_pk_fma_f32 v[4:5], v[232:233], v[2:3], v[4:5] op_sel:[1,1,0] op_sel_hi:[1,0,1] neg_lo:[0,1,0]
v_pk_fma_f32 v[2:3], v[232:233], v[4:5], v[158:159] op_sel_hi:[0,1,1]
v_pk_fma_f32 v[2:3], v[232:233], v[4:5], v[2:3] op_sel:[1,1,0] op_sel_hi:[1,0,1] neg_lo:[0,1,0]
v_pk_fma_f32 v[4:5], v[232:233], v[2:3], v[160:161] op_sel_hi:[0,1,1]
v_pk_fma_f32 v[4:5], v[232:233], v[2:3], v[4:5] op_sel:[1,1,0] op_sel_hi:[1,0,1] neg_lo:[0,1,0]
v_pk_fma_f32 v[2:3], v[232:233], v[4:5], v[162:163] op_sel_hi:[0,1,1]
v_pk_fma_f32 v[2:3], v[232:233], v[4:5], v[2:3] op_sel:[1,1,0] op_sel_hi:[1,0,1] neg_lo:[0,1,0]
v_min_u32 v2, -2, v2
v_min_u32 v3, -2, v3
buffer_store_dwordx2 v[2:3], v196, s[20:23], 0 offen sc1
v_accvgpr_read_b32 v14, a215
s_bfm_b64 s[98:99], s88, 0
s_add_u32 m0, s94, 122880
s_nop 0
buffer_load_dwordx4 v238, s[12:15], s96 offen offset:0  lds
v_pk_mul_f32 v[2:3], v[220:221], v[36:37] op_sel:[1,0] op_sel_hi:[1,1] neg_lo:[1,0] neg_hi:[1,0]
v_pk_mul_f32 v[36:37], v[220:221], v[36:37] op_sel_hi:[0,1] neg_lo:[1,0] neg_hi:[1,0]
v_pk_fma_f32 v[36:37], v[220:221], v[16:17], v[36:37] op_sel:[1,0,0] op_sel_hi:[1,1,1] neg_lo:[1,0,0] neg_hi:[1,0,0]
v_pk_fma_f32 v[16:17], v[220:221], v[16:17], v[2:3] op_sel_hi:[0,1,1]
v_pk_mul_f32 v[2:3], v[220:221], v[38:39] op_sel:[1,0] op_sel_hi:[1,1] neg_lo:[1,0] neg_hi:[1,0]
v_pk_mul_f32 v[38:39], v[220:221], v[38:39] op_sel_hi:[0,1] neg_lo:[1,0] neg_hi:[1,0]
v_pk_fma_f32 v[38:39], v[220:221], v[18:19], v[38:39] op_sel:[1,0,0] op_sel_hi:[1,1,1] neg_lo:[1,0,0] neg_hi:[1,0,0]
v_pk_fma_f32 v[18:19], v[220:221], v[18:19], v[2:3] op_sel_hi:[0,1,1]
v_pk_mul_f32 v[2:3], v[220:221], v[76:77] op_sel:[1,0] op_sel_hi:[1,1] neg_lo:[1,0] neg_hi:[1,0]
v_pk_mul_f32 v[76:77], v[220:221], v[76:77] op_sel_hi:[0,1] neg_lo:[1,0] neg_hi:[1,0]
v_pk_fma_f32 v[76:77], v[220:221], v[56:57], v[76:77] op_sel:[1,0,0] op_sel_hi:[1,1,1] neg_lo:[1,0,0] neg_hi:[1,0,0]
buffer_load_dwordx4 v239, s[12:15], s96 offen offset:1024  lds
v_pk_fma_f32 v[56:57], v[220:221], v[56:57], v[2:3] op_sel_hi:[0,1,1]
v_pk_mul_f32 v[2:3], v[220:221], v[78:79] op_sel:[1,0] op_sel_hi:[1,1] neg_lo:[1,0] neg_hi:[1,0]
v_pk_mul_f32 v[78:79], v[220:221], v[78:79] op_sel_hi:[0,1] neg_lo:[1,0] neg_hi:[1,0]
v_pk_fma_f32 v[78:79], v[220:221], v[58:59], v[78:79] op_sel:[1,0,0] op_sel_hi:[1,1,1] neg_lo:[1,0,0] neg_hi:[1,0,0]
v_pk_fma_f32 v[58:59], v[220:221], v[58:59], v[2:3] op_sel_hi:[0,1,1]
v_pk_mul_f32 v[2:3], v[222:223], v[40:41] op_sel:[1,0] op_sel_hi:[1,1] neg_lo:[1,0] neg_hi:[1,0]
v_pk_mul_f32 v[40:41], v[222:223], v[40:41] op_sel_hi:[0,1] neg_lo:[1,0] neg_hi:[1,0]
v_pk_fma_f32 v[40:41], v[222:223], v[20:21], v[40:41] op_sel:[1,0,0] op_sel_hi:[1,1,1] neg_lo:[1,0,0] neg_hi:[1,0,0]
v_pk_fma_f32 v[20:21], v[222:223], v[20:21], v[2:3] op_sel_hi:[0,1,1]
v_pk_mul_f32 v[2:3], v[222:223], v[42:43] op_sel:[1,0] op_sel_hi:[1,1] neg_lo:[1,0] neg_hi:[1,0]
v_pk_mul_f32 v[42:43], v[222:223], v[42:43] op_sel_hi:[0,1] neg_lo:[1,0] neg_hi:[1,0]
buffer_load_dwordx4 v240, s[12:15], s96 offen offset:2048  lds
v_pk_fma_f32 v[42:43], v[222:223], v[22:23], v[42:43] op_sel:[1,0,0] op_sel_hi:[1,1,1] neg_lo:[1,0,0] neg_hi:[1,0,0]
v_pk_fma_f32 v[22:23], v[222:223], v[22:23], v[2:3] op_sel_hi:[0,1,1]
v_pk_mul_f32 v[2:3], v[222:223], v[80:81] op_sel:[1,0] op_sel_hi:[1,1] neg_lo:[1,0] neg_hi:[1,0]
v_pk_mul_f32 v[80:81], v[222:223], v[80:81] op_sel_hi:[0,1] neg_lo:[1,0] neg_hi:[1,0]
v_pk_fma_f32 v[80:81], v[222:223], v[60:61], v[80:81] op_sel:[1,0,0] op_sel_hi:[1,1,1] neg_lo:[1,0,0] neg_hi:[1,0,0]
v_pk_fma_f32 v[60:61], v[222:223], v[60:61], v[2:3] op_sel_hi:[0,1,1]
v_pk_mul_f32 v[2:3], v[222:223], v[82:83] op_sel:[1,0] op_sel_hi:[1,1] neg_lo:[1,0] neg_hi:[1,0]
v_pk_mul_f32 v[82:83], v[222:223], v[82:83] op_sel_hi:[0,1] neg_lo:[1,0] neg_hi:[1,0]
v_pk_fma_f32 v[82:83], v[222:223], v[62:63], v[82:83] op_sel:[1,0,0] op_sel_hi:[1,1,1] neg_lo:[1,0,0] neg_hi:[1,0,0]
v_pk_fma_f32 v[62:63], v[222:223], v[62:63], v[2:3] op_sel_hi:[0,1,1]
v_pk_mul_f32 v[2:3], v[224:225], v[44:45] op_sel:[1,0] op_sel_hi:[1,1] neg_lo:[1,0] neg_hi:[1,0]
buffer_load_dwordx4 v241, s[12:15], s96 offen offset:3072  lds
v_pk_mul_f32 v[44:45], v[224:225], v[44:45] op_sel_hi:[0,1] neg_lo:[1,0] neg_hi:[1,0]
v_pk_fma_f32 v[44:45], v[224:225], v[24:25], v[44:45] op_sel:[1,0,0] op_sel_hi:[1,1,1] neg_lo:[1,0,0] neg_hi:[1,0,0]
v_pk_fma_f32 v[24:25], v[224:225], v[24:25], v[2:3] op_sel_hi:[0,1,1]
v_pk_mul_f32 v[2:3], v[224:225], v[46:47] op_sel:[1,0] op_sel_hi:[1,1] neg_lo:[1,0] neg_hi:[1,0]
v_pk_mul_f32 v[46:47], v[224:225], v[46:47] op_sel_hi:[0,1] neg_lo:[1,0] neg_hi:[1,0]
v_pk_fma_f32 v[46:47], v[224:225], v[26:27], v[46:47] op_sel:[1,0,0] op_sel_hi:[1,1,1] neg_lo:[1,0,0] neg_hi:[1,0,0]
v_pk_fma_f32 v[26:27], v[224:225], v[26:27], v[2:3] op_sel_hi:[0,1,1]
v_pk_mul_f32 v[2:3], v[224:225], v[84:85] op_sel:[1,0] op_sel_hi:[1,1] neg_lo:[1,0] neg_hi:[1,0]
v_pk_mul_f32 v[84:85], v[224:225], v[84:85] op_sel_hi:[0,1] neg_lo:[1,0] neg_hi:[1,0]
v_pk_fma_f32 v[84:85], v[224:225], v[64:65], v[84:85] op_sel:[1,0,0] op_sel_hi:[1,1,1] neg_lo:[1,0,0] neg_hi:[1,0,0]
v_pk_fma_f32 v[64:65], v[224:225], v[64:65], v[2:3] op_sel_hi:[0,1,1]
s_add_u32 m0, s94, 126976
s_nop 0
buffer_load_dwordx4 v242, s[12:15], s96 offen offset:0  lds
v_pk_mul_f32 v[2:3], v[224:225], v[86:87] op_sel:[1,0] op_sel_hi:[1,1] neg_lo:[1,0] neg_hi:[1,0]
v_pk_mul_f32 v[86:87], v[224:225], v[86:87] op_sel_hi:[0,1] neg_lo:[1,0] neg_hi:[1,0]
v_pk_fma_f32 v[86:87], v[224:225], v[66:67], v[86:87] op_sel:[1,0,0] op_sel_hi:[1,1,1] neg_lo:[1,0,0] neg_hi:[1,0,0]
v_pk_fma_f32 v[66:67], v[224:225], v[66:67], v[2:3] op_sel_hi:[0,1,1]
v_pk_mul_f32 v[2:3], v[226:227], v[48:49] op_sel:[1,0] op_sel_hi:[1,1] neg_lo:[1,0] neg_hi:[1,0]
v_pk_mul_f32 v[48:49], v[226:227], v[48:49] op_sel_hi:[0,1] neg_lo:[1,0] neg_hi:[1,0]
v_pk_fma_f32 v[48:49], v[226:227], v[28:29], v[48:49] op_sel:[1,0,0] op_sel_hi:[1,1,1] neg_lo:[1,0,0] neg_hi:[1,0,0]
v_pk_fma_f32 v[28:29], v[226:227], v[28:29], v[2:3] op_sel_hi:[0,1,1]
v_pk_mul_f32 v[2:3], v[226:227], v[50:51] op_sel:[1,0] op_sel_hi:[1,1] neg_lo:[1,0] neg_hi:[1,0]
v_pk_mul_f32 v[50:51], v[226:227], v[50:51] op_sel_hi:[0,1] neg_lo:[1,0] neg_hi:[1,0]
v_pk_fma_f32 v[50:51], v[226:227], v[30:31], v[50:51] op_sel:[1,0,0] op_sel_hi:[1,1,1] neg_lo:[1,0,0] neg_hi:[1,0,0]
buffer_load_dwordx4 v243, s[12:15], s96 offen offset:1024  lds
v_pk_fma_f32 v[30:31], v[226:227], v[30:31], v[2:3] op_sel_hi:[0,1,1]
v_pk_mul_f32 v[2:3], v[226:227], v[88:89] op_sel:[1,0] op_sel_hi:[1,1] neg_lo:[1,0] neg_hi:[1,0]
v_pk_mul_f32 v[88:89], v[226:227], v[88:89] op_sel_hi:[0,1] neg_lo:[1,0] neg_hi:[1,0]
v_pk_fma_f32 v[88:89], v[226:227], v[68:69], v[88:89] op_sel:[1,0,0] op_sel_hi:[1,1,1] neg_lo:[1,0,0] neg_hi:[1,0,0]
v_pk_fma_f32 v[68:69], v[226:227], v[68:69], v[2:3] op_sel_hi:[0,1,1]
v_pk_mul_f32 v[2:3], v[226:227], v[90:91] op_sel:[1,0] op_sel_hi:[1,1] neg_lo:[1,0] neg_hi:[1,0]
v_pk_mul_f32 v[90:91], v[226:227], v[90:91] op_sel_hi:[0,1] neg_lo:[1,0] neg_hi:[1,0]
v_pk_fma_f32 v[90:91], v[226:227], v[70:71], v[90:91] op_sel:[1,0,0] op_sel_hi:[1,1,1] neg_lo:[1,0,0] neg_hi:[1,0,0]
v_pk_fma_f32 v[70:71], v[226:227], v[70:71], v[2:3] op_sel_hi:[0,1,1]
v_pk_mul_f32 v[2:3], v[228:229], v[52:53] op_sel:[1,0] op_sel_hi:[1,1] neg_lo:[1,0] neg_hi:[1,0]
v_pk_mul_f32 v[52:53], v[228:229], v[52:53] op_sel_hi:[0,1] neg_lo:[1,0] neg_hi:[1,0]
buffer_load_dwordx4 v244, s[12:15], s96 offen offset:2048  lds
v_pk_fma_f32 v[52:53], v[228:229], v[32:33], v[52:53] op_sel:[1,0,0] op_sel_hi:[1,1,1] neg_lo:[1,0,0] neg_hi:[1,0,0]
v_pk_fma_f32 v[32:33], v[228:229], v[32:33], v[2:3] op_sel_hi:[0,1,1]
v_pk_mul_f32 v[2:3], v[228:229], v[54:55] op_sel:[1,0] op_sel_hi:[1,1] neg_lo:[1,0] neg_hi:[1,0]
v_pk_mul_f32 v[54:55], v[228:229], v[54:55] op_sel_hi:[0,1] neg_lo:[1,0] neg_hi:[1,0]
v_pk_fma_f32 v[54:55], v[228:229], v[34:35], v[54:55] op_sel:[1,0,0] op_sel_hi:[1,1,1] neg_lo:[1,0,0] neg_hi:[1,0,0]
v_pk_fma_f32 v[34:35], v[228:229], v[34:35], v[2:3] op_sel_hi:[0,1,1]
v_pk_mul_f32 v[2:3], v[228:229], v[92:93] op_sel:[1,0] op_sel_hi:[1,1] neg_lo:[1,0] neg_hi:[1,0]
v_pk_mul_f32 v[92:93], v[228:229], v[92:93] op_sel_hi:[0,1] neg_lo:[1,0] neg_hi:[1,0]
v_pk_fma_f32 v[92:93], v[228:229], v[72:73], v[92:93] op_sel:[1,0,0] op_sel_hi:[1,1,1] neg_lo:[1,0,0] neg_hi:[1,0,0]
v_pk_fma_f32 v[72:73], v[228:229], v[72:73], v[2:3] op_sel_hi:[0,1,1]
v_pk_mul_f32 v[2:3], v[228:229], v[94:95] op_sel:[1,0] op_sel_hi:[1,1] neg_lo:[1,0] neg_hi:[1,0]
buffer_load_dwordx4 v245, s[12:15], s96 offen offset:3072  lds
v_pk_mul_f32 v[94:95], v[228:229], v[94:95] op_sel_hi:[0,1] neg_lo:[1,0] neg_hi:[1,0]
v_pk_fma_f32 v[94:95], v[228:229], v[74:75], v[94:95] op_sel:[1,0,0] op_sel_hi:[1,1,1] neg_lo:[1,0,0] neg_hi:[1,0,0]
v_pk_fma_f32 v[74:75], v[228:229], v[74:75], v[2:3] op_sel_hi:[0,1,1]
v_pk_mul_f32 v[2:3], v[236:237], v[132:133] op_sel_hi:[0,1] neg_hi:[1,0]
v_pk_fma_f32 v[132:133], v[236:237], v[132:133], v[2:3] op_sel:[1,1,0] op_sel_hi:[1,0,1] neg_lo:[1,0,0] neg_hi:[1,0,0]
v_pk_mul_f32 v[2:3], v[236:237], v[134:135] op_sel_hi:[0,1] neg_hi:[1,0]
v_pk_fma_f32 v[134:135], v[236:237], v[134:135], v[2:3] op_sel:[1,1,0] op_sel_hi:[1,0,1] neg_lo:[1,0,0] neg_hi:[1,0,0]
v_pk_mul_f32 v[2:3], v[236:237], v[136:137] op_sel_hi:[0,1] neg_hi:[1,0]
v_pk_fma_f32 v[136:137], v[236:237], v[136:137], v[2:3] op_sel:[1,1,0] op_sel_hi:[1,0,1] neg_lo:[1,0,0] neg_hi:[1,0,0]
v_pk_mul_f32 v[2:3], v[236:237], v[138:139] op_sel_hi:[0,1] neg_hi:[1,0]
v_pk_fma_f32 v[138:139], v[236:237], v[138:139], v[2:3] op_sel:[1,1,0] op_sel_hi:[1,0,1] neg_lo:[1,0,0] neg_hi:[1,0,0]
s_add_u32 m0, s94, 131072
s_nop 0
buffer_load_dwordx4 v246, s[12:15], s96 offen offset:0  lds
v_pk_mul_f32 v[2:3], v[236:237], v[140:141] op_sel_hi:[0,1] neg_hi:[1,0]
v_pk_fma_f32 v[140:141], v[236:237], v[140:141], v[2:3] op_sel:[1,1,0] op_sel_hi:[1,0,1] neg_lo:[1,0,0] neg_hi:[1,0,0]
v_pk_mul_f32 v[2:3], v[236:237], v[142:143] op_sel_hi:[0,1] neg_hi:[1,0]
v_pk_fma_f32 v[142:143], v[236:237], v[142:143], v[2:3] op_sel:[1,1,0] op_sel_hi:[1,0,1] neg_lo:[1,0,0] neg_hi:[1,0,0]
v_pk_mul_f32 v[2:3], v[236:237], v[144:145] op_sel_hi:[0,1] neg_hi:[1,0]
v_pk_fma_f32 v[144:145], v[236:237], v[144:145], v[2:3] op_sel:[1,1,0] op_sel_hi:[1,0,1] neg_lo:[1,0,0] neg_hi:[1,0,0]
v_pk_mul_f32 v[2:3], v[236:237], v[146:147] op_sel_hi:[0,1] neg_hi:[1,0]
v_pk_fma_f32 v[146:147], v[236:237], v[146:147], v[2:3] op_sel:[1,1,0] op_sel_hi:[1,0,1] neg_lo:[1,0,0] neg_hi:[1,0,0]
v_pk_mul_f32 v[2:3], v[236:237], v[148:149] op_sel_hi:[0,1] neg_hi:[1,0]
v_pk_fma_f32 v[148:149], v[236:237], v[148:149], v[2:3] op_sel:[1,1,0] op_sel_hi:[1,0,1] neg_lo:[1,0,0] neg_hi:[1,0,0]
v_pk_mul_f32 v[2:3], v[236:237], v[150:151] op_sel_hi:[0,1] neg_hi:[1,0]
buffer_load_dwordx4 v247, s[12:15], s96 offen offset:1024  lds
s_add_u32 s96, s96, 128
s_cmp_eq_u32 s96, 640
s_cselect_b32 s96, 0, s96
v_pk_fma_f32 v[150:151], v[236:237], v[150:151], v[2:3] op_sel:[1,1,0] op_sel_hi:[1,0,1] neg_lo:[1,0,0] neg_hi:[1,0,0]
v_pk_mul_f32 v[2:3], v[236:237], v[152:153] op_sel_hi:[0,1] neg_hi:[1,0]
v_pk_fma_f32 v[152:153], v[236:237], v[152:153], v[2:3] op_sel:[1,1,0] op_sel_hi:[1,0,1] neg_lo:[1,0,0] neg_hi:[1,0,0]
v_pk_mul_f32 v[2:3], v[236:237], v[154:155] op_sel_hi:[0,1] neg_hi:[1,0]
v_pk_fma_f32 v[154:155], v[236:237], v[154:155], v[2:3] op_sel:[1,1,0] op_sel_hi:[1,0,1] neg_lo:[1,0,0] neg_hi:[1,0,0]
v_pk_mul_f32 v[2:3], v[236:237], v[156:157] op_sel_hi:[0,1] neg_hi:[1,0]
v_pk_fma_f32 v[156:157], v[236:237], v[156:157], v[2:3] op_sel:[1,1,0] op_sel_hi:[1,0,1] neg_lo:[1,0,0] neg_hi:[1,0,0]
v_pk_mul_f32 v[2:3], v[236:237], v[158:159] op_sel_hi:[0,1] neg_hi:[1,0]
v_pk_fma_f32 v[158:159], v[236:237], v[158:159], v[2:3] op_sel:[1,1,0] op_sel_hi:[1,0,1] neg_lo:[1,0,0] neg_hi:[1,0,0]
v_pk_mul_f32 v[2:3], v[236:237], v[160:161] op_sel_hi:[0,1] neg_hi:[1,0]
v_pk_fma_f32 v[160:161], v[236:237], v[160:161], v[2:3] op_sel:[1,1,0] op_sel_hi:[1,0,1] neg_lo:[1,0,0] neg_hi:[1,0,0]
s_mov_b32 s100, 0
s_waitcnt vmcnt(15)
L_clr:
v_cmp_ne_u64 vcc, v[6:7], v[186:187]
s_add_u32 s100, s100, 1
s_nop 0
s_and_b64 vcc, vcc, s[98:99]
s_cbranch_scc1 L_clr_slow
L_clr_ok:
s_mov_b32 s100, 0
s_mov_b64 exec, 0xfffff
buffer_load_dwordx2 v[96:97], v14, s[20:23], 0 offen offset:0 sc1
buffer_load_dwordx2 v[98:99], v14, s[20:23], 0 offen offset:640 sc1
buffer_load_dwordx2 v[100:101], v14, s[20:23], 0 offen offset:1280 sc1
buffer_load_dwordx2 v[102:103], v14, s[20:23], 0 offen offset:1920 sc1
buffer_load_dwordx2 v[104:105], v14, s[20:23], 0 offen offset:2560 sc1
buffer_load_dwordx2 v[106:107], v14, s[20:23], 0 offen offset:3200 sc1
buffer_load_dwordx2 v[108:109], v14, s[20:23], s56 offen offset:0 sc1
buffer_load_dwordx2 v[110:111], v14, s[20:23], s56 offen offset:640 sc1
buffer_load_dwordx2 v[112:113], v14, s[20:23], s56 offen offset:1280 sc1
buffer_load_dwordx2 v[114:115], v14, s[20:23], s56 offen offset:1920 sc1
buffer_load_dwordx2 v[116:117], v14, s[20:23], s56 offen offset:2560 sc1
buffer_load_dwordx2 v[118:119], v14, s[20:23], s56 offen offset:3200 sc1
buffer_load_dwordx2 v[120:121], v14, s[20:23], s57 offen offset:0 sc1
buffer_load_dwordx2 v[122:123], v14, s[20:23], s57 offen offset:640 sc1
buffer_load_dwordx2 v[124:125], v14, s[20:23], s57 offen offset:1280 sc1
s_mov_b64 exec, -1
v_accvgpr_read_b32 v9, a200
v_accvgpr_read_b32 v11, a201
v_accvgpr_read_b32 v15, a202
v_accvgpr_read_b32 v8, a203
v_accvgpr_read_b32 v255, a216
v_accvgpr_read_b32 v13, a217
v_accvgpr_read_b32 v220, a204
v_accvgpr_read_b32 v221, a205
v_accvgpr_read_b32 v222, a206
v_accvgpr_read_b32 v223, a207
v_accvgpr_read_b32 v224, a208
v_accvgpr_read_b32 v225, a209
v_accvgpr_read_b32 v174, a211
v_accvgpr_read_b32 v175, a212
v_accvgpr_read_b32 v176, a213
v_accvgpr_read_b32 v177, a210
s_waitcnt vmcnt(27)
ds_read_b128 a[0:3], v181 offset:0
ds_read_b128 a[4:7], v181 offset:2048
ds_read_b128 a[8:11], v181 offset:4096
ds_read_b128 a[12:15], v181 offset:6144
ds_read_b128 a[16:19], v181 offset:8192
ds_read_b128 a[20:23], v184 offset:0
ds_read_b128 a[24:27], v184 offset:2048
ds_read_b128 a[28:31], v184 offset:4096
ds_read_b128 a[32:35], v184 offset:6144
ds_read_b128 a[36:39], v184 offset:8192
s_waitcnt vmcnt(15)
ds_read_b128 a[40:43], v182 offset:0
ds_read_b128 a[44:47], v182 offset:2048
ds_read_b128 a[48:51], v182 offset:4096
ds_read_b128 a[52:55], v182 offset:6144
ds_read_b128 a[56:59], v182 offset:8192
ds_read_b128 a[60:63], v185 offset:0
ds_read_b128 a[64:67], v185 offset:2048
ds_read_b128 a[68:71], v185 offset:4096
ds_read_b128 a[72:75], v185 offset:6144
ds_read_b128 a[76:79], v185 offset:8192
s_mov_b64 exec, 0xfffff
s_waitcnt vmcnt(0)
L_ep_chk:
v_max3_u32 v2, v96, v97, v98
v_max3_u32 v2, v2, v99, v100
v_max3_u32 v2, v2, v101, v102
v_max3_u32 v2, v2, v103, v104
v_max3_u32 v2, v2, v105, v106
v_max3_u32 v2, v2, v107, v108
v_max3_u32 v2, v2, v109, v110
v_max3_u32 v2, v2, v111, v112
v_max3_u32 v2, v2, v113, v114
v_max3_u32 v2, v2, v115, v116
v_max3_u32 v2, v2, v117, v118
v_max3_u32 v2, v2, v119, v120
v_max3_u32 v2, v2, v121, v122
v_max3_u32 v2, v2, v123, v124
v_max_u32 v2, v2, v125
v_cmp_eq_u32 vcc, -1, v2
s_add_u32 s100, s100, 1
s_cbranch_vccnz L_ep_slow
L_ep_ok:
.p2align 3
s_mov_b64 exec, -1
v_pk_fma_f32 v[122:123], v[234:235], v[124:125], v[122:123] op_sel_hi:[0,1,1]
v_pk_fma_f32 v[122:123], v[234:235], v[124:125], v[122:123] op_sel:[1,1,0] op_sel_hi:[1,0,1] neg_lo:[0,1,0]
v_pk_fma_f32 v[120:121], v[234:235], v[122:123], v[120:121] op_sel_hi:[0,1,1]
v_pk_fma_f32 v[120:121], v[234:235], v[122:123], v[120:121] op_sel:[1,1,0] op_sel_hi:[1,0,1] neg_lo:[0,1,0]
v_pk_fma_f32 v[118:119], v[234:235], v[120:121], v[118:119] op_sel_hi:[0,1,1]
v_pk_fma_f32 v[118:119], v[234:235], v[120:121], v[118:119] op_sel:[1,1,0] op_sel_hi:[1,0,1] neg_lo:[0,1,0]
v_pk_fma_f32 v[116:117], v[234:235], v[118:119], v[116:117] op_sel_hi:[0,1,1]
v_pk_fma_f32 v[116:117], v[234:235], v[118:119], v[116:117] op_sel:[1,1,0] op_sel_hi:[1,0,1] neg_lo:[0,1,0]
v_pk_fma_f32 v[114:115], v[234:235], v[116:117], v[114:115] op_sel_hi:[0,1,1]
v_pk_fma_f32 v[114:115], v[234:235], v[116:117], v[114:115] op_sel:[1,1,0] op_sel_hi:[1,0,1] neg_lo:[0,1,0]
v_pk_fma_f32 v[112:113], v[234:235], v[114:115], v[112:113] op_sel_hi:[0,1,1]
v_pk_fma_f32 v[112:113], v[234:235], v[114:115], v[112:113] op_sel:[1,1,0] op_sel_hi:[1,0,1] neg_lo:[0,1,0]
v_pk_fma_f32 v[110:111], v[234:235], v[112:113], v[110:111] op_sel_hi:[0,1,1]
v_pk_fma_f32 v[110:111], v[234:235], v[112:113], v[110:111] op_sel:[1,1,0] op_sel_hi:[1,0,1] neg_lo:[0,1,0]
v_pk_fma_f32 v[108:109], v[234:235], v[110:111], v[108:109] op_sel_hi:[0,1,1]
v_pk_fma_f32 v[108:109], v[234:235], v[110:111], v[108:109] op_sel:[1,1,0] op_sel_hi:[1,0,1] neg_lo:[0,1,0]
v_pk_fma_f32 v[106:107], v[234:235], v[108:109], v[106:107] op_sel_hi:[0,1,1]
v_pk_fma_f32 v[106:107], v[234:235], v[108:109], v[106:107] op_sel:[1,1,0] op_sel_hi:[1,0,1] neg_lo:[0,1,0]
v_pk_fma_f32 v[104:105], v[234:235], v[106:107], v[104:105] op_sel_hi:[0,1,1]
v_pk_fma_f32 v[104:105], v[234:235], v[106:107], v[104:105] op_sel:[1,1,0] op_sel_hi:[1,0,1] neg_lo:[0,1,0]
v_pk_fma_f32 v[102:103], v[234:235], v[104:105], v[102:103] op_sel_hi:[0,1,1]
v_pk_fma_f32 v[102:103], v[234:235], v[104:105], v[102:103] op_sel:[1,1,0] op_sel_hi:[1,0,1] neg_lo:[0,1,0]
v_pk_fma_f32 v[100:101], v[234:235], v[102:103], v[100:101] op_sel_hi:[0,1,1]
v_pk_fma_f32 v[100:101], v[234:235], v[102:103], v[100:101] op_sel:[1,1,0] op_sel_hi:[1,0,1] neg_lo:[0,1,0]
v_pk_fma_f32 v[98:99], v[234:235], v[100:101], v[98:99] op_sel_hi:[0,1,1]
v_pk_fma_f32 v[98:99], v[234:235], v[100:101], v[98:99] op_sel:[1,1,0] op_sel_hi:[1,0,1] neg_lo:[0,1,0]
v_pk_fma_f32 v[96:97], v[234:235], v[98:99], v[96:97] op_sel_hi:[0,1,1]
v_pk_fma_f32 v[96:97], v[234:235], v[98:99], v[96:97] op_sel:[1,1,0] op_sel_hi:[1,0,1] neg_lo:[0,1,0]
v_pk_mul_f32 v[2:3], v[236:237], v[96:97] op_sel_hi:[0,1] neg_hi:[1,0]
v_pk_fma_f32 v[130:131], v[236:237], v[96:97], v[2:3] op_sel:[1,1,0] op_sel_hi:[1,0,1] neg_lo:[1,0,0] neg_hi:[1,0,0]
v_pk_fma_f32 v[132:133], v[232:233], v[130:131], v[132:133] op_sel_hi:[0,1,1]
v_pk_fma_f32 v[132:133], v[232:233], v[130:131], v[132:133] op_sel:[1,1,0] op_sel_hi:[1,0,1] neg_hi:[1,0,0]
ds_write_b128 v13, v[130:133] offset:0
v_pk_fma_f32 v[134:135], v[232:233], v[132:133], v[134:135] op_sel_hi:[0,1,1]
v_pk_fma_f32 v[134:135], v[232:233], v[132:133], v[134:135] op_sel:[1,1,0] op_sel_hi:[1,0,1] neg_hi:[1,0,0]
v_pk_fma_f32 v[136:137], v[232:233], v[134:135], v[136:137] op_sel_hi:[0,1,1]
v_pk_fma_f32 v[136:137], v[232:233], v[134:135], v[136:137] op_sel:[1,1,0] op_sel_hi:[1,0,1] neg_hi:[1,0,0]
ds_write_b128 v13, v[134:137] offset:16
v_pk_fma_f32 v[138:139], v[232:233], v[136:137], v[138:139] op_sel_hi:[0,1,1]
v_pk_fma_f32 v[138:139], v[232:233], v[136:137], v[138:139] op_sel:[1,1,0] op_sel_hi:[1,0,1] neg_hi:[1,0,0]
v_pk_fma_f32 v[140:141], v[232:233], v[138:139], v[140:141] op_sel_hi:[0,1,1]
v_pk_fma_f32 v[140:141], v[232:233], v[138:139], v[140:141] op_sel:[1,1,0] op_sel_hi:[1,0,1] neg_hi:[1,0,0]
ds_write_b128 v13, v[138:141] offset:32
v_pk_fma_f32 v[142:143], v[232:233], v[140:141], v[142:143] op_sel_hi:[0,1,1]
v_pk_fma_f32 v[142:143], v[232:233], v[140:141], v[142:143] op_sel:[1,1,0] op_sel_hi:[1,0,1] neg_hi:[1,0,0]
v_pk_fma_f32 v[144:145], v[232:233], v[142:143], v[144:145] op_sel_hi:[0,1,1]
v_pk_fma_f32 v[144:145], v[232:233], v[142:143], v[144:145] op_sel:[1,1,0] op_sel_hi:[1,0,1] neg_hi:[1,0,0]
ds_write_b128 v13, v[142:145] offset:48
v_pk_fma_f32 v[146:147], v[232:233], v[144:145], v[146:147] op_sel_hi:[0,1,1]
v_pk_fma_f32 v[146:147], v[232:233], v[144:145], v[146:147] op_sel:[1,1,0] op_sel_hi:[1,0,1] neg_hi:[1,0,0]
v_pk_fma_f32 v[148:149], v[232:233], v[146:147], v[148:149] op_sel_hi:[0,1,1]
v_pk_fma_f32 v[148:149], v[232:233], v[146:147], v[148:149] op_sel:[1,1,0] op_sel_hi:[1,0,1] neg_hi:[1,0,0]
ds_write_b128 v13, v[146:149] offset:64
v_pk_fma_f32 v[150:151], v[232:233], v[148:149], v[150:151] op_sel_hi:[0,1,1]
v_pk_fma_f32 v[150:151], v[232:233], v[148:149], v[150:151] op_sel:[1,1,0] op_sel_hi:[1,0,1] neg_hi:[1,0,0]
v_pk_fma_f32 v[152:153], v[232:233], v[150:151], v[152:153] op_sel_hi:[0,1,1]
v_pk_fma_f32 v[152:153], v[232:233], v[150:151], v[152:153] op_sel:[1,1,0] op_sel_hi:[1,0,1] neg_hi:[1,0,0]
ds_write_b128 v13, v[150:153] offset:80
v_pk_fma_f32 v[154:155], v[232:233], v[152:153], v[154:155] op_sel_hi:[0,1,1]
v_pk_fma_f32 v[154:155], v[232:233], v[152:153], v[154:155] op_sel:[1,1,0] op_sel_hi:[1,0,1] neg_hi:[1,0,0]
v_pk_fma_f32 v[156:157], v[232:233], v[154:155], v[156:157] op_sel_hi:[0,1,1]
v_pk_fma_f32 v[156:157], v[232:233], v[154:155], v[156:157] op_sel:[1,1,0] op_sel_hi:[1,0,1] neg_hi:[1,0,0]
ds_write_b128 v13, v[154:157] offset:96
v_pk_fma_f32 v[158:159], v[232:233], v[156:157], v[158:159] op_sel_hi:[0,1,1]
v_pk_fma_f32 v[158:159], v[232:233], v[156:157], v[158:159] op_sel:[1,1,0] op_sel_hi:[1,0,1] neg_hi:[1,0,0]
v_pk_fma_f32 v[160:161], v[232:233], v[158:159], v[160:161] op_sel_hi:[0,1,1]
v_pk_fma_f32 v[160:161], v[232:233], v[158:159], v[160:161] op_sel:[1,1,0] op_sel_hi:[1,0,1] neg_hi:[1,0,0]
ds_write_b128 v13, v[158:161] offset:112
buffer_load_dwordx4 v[160:163], v177, s[16:19], 0 offen sc1
buffer_load_dwordx2 v[148:149], v220, s[36:39], 0 offen
buffer_load_dwordx2 v[150:151], v220, s[40:43], 0 offen
buffer_load_dwordx2 v[226:227], v223, s[4:7], s62 offen
buffer_load_dwordx2 v[232:233], v223, s[4:7], s64 offen
buffer_load_dwordx2 v[152:153], v221, s[36:39], 0 offen
buffer_load_dwordx2 v[154:155], v221, s[40:43], 0 offen
buffer_load_dwordx2 v[228:229], v224, s[4:7], s62 offen
buffer_load_dwordx2 v[234:235], v224, s[4:7], s64 offen
buffer_load_dwordx2 v[156:157], v222, s[36:39], 0 offen
buffer_load_dwordx2 v[158:159], v222, s[40:43], 0 offen
buffer_load_dwordx2 v[230:231], v225, s[4:7], s62 offen
buffer_load_dwordx2 v[236:237], v225, s[4:7], s64 offen
s_waitcnt lgkmcnt(0)
s_barrier
ds_read_b64 v[96:97], v12 offset:11520
ds_read_b64 v[100:101], v12 offset:13824
ds_read_b64 v[104:105], v12 offset:16128
ds_read_b64 v[108:109], v12 offset:18432
ds_read_b64 v[112:113], v12 offset:20736
.p2align 3
s_waitcnt lgkmcnt(4)
v_mov_b32 v98, v97
v_fma_f32 v99, v202, v97, v165
v_fma_f32 v97, v202, v96, v164
v_fma_f32 v99, -v203, v96, v99
v_fma_f32 v97, v203, v98, v97
v_pk_fma_f32 v[16:17], v[200:201], v[96:97], v[16:17] op_sel_hi:[0,1,1]
v_pk_fma_f32 v[36:37], v[200:201], v[98:99], v[36:37] op_sel_hi:[0,1,1]
v_pk_fma_f32 v[16:17], v[200:201], v[98:99], v[16:17] op_sel:[1,0,0] op_sel_hi:[1,1,1]
v_pk_fma_f32 v[36:37], v[200:201], v[96:97], v[36:37] op_sel:[1,0,0] op_sel_hi:[1,1,1] neg_lo:[1,0,0] neg_hi:[1,0,0]
v_pk_fma_f32 v[18:19], v[200:201], v[16:17], v[18:19] op_sel_hi:[0,1,1]
v_pk_fma_f32 v[38:39], v[200:201], v[36:37], v[38:39] op_sel_hi:[0,1,1]
v_pk_fma_f32 v[18:19], v[200:201], v[36:37], v[18:19] op_sel:[1,0,0] op_sel_hi:[1,1,1]
v_pk_fma_f32 v[38:39], v[200:201], v[16:17], v[38:39] op_sel:[1,0,0] op_sel_hi:[1,1,1] neg_lo:[1,0,0] neg_hi:[1,0,0]
v_pk_fma_f32 v[56:57], v[200:201], v[18:19], v[56:57] op_sel_hi:[0,1,1]
v_pk_fma_f32 v[76:77], v[200:201], v[38:39], v[76:77] op_sel_hi:[0,1,1]
v_pk_fma_f32 v[56:57], v[200:201], v[38:39], v[56:57] op_sel:[1,0,0] op_sel_hi:[1,1,1]
v_pk_fma_f32 v[76:77], v[200:201], v[18:19], v[76:77] op_sel:[1,0,0] op_sel_hi:[1,1,1] neg_lo:[1,0,0] neg_hi:[1,0,0]
v_pk_fma_f32 v[58:59], v[200:201], v[56:57], v[58:59] op_sel_hi:[0,1,1]
v_pk_fma_f32 v[78:79], v[200:201], v[76:77], v[78:79] op_sel_hi:[0,1,1]
v_pk_fma_f32 v[58:59], v[200:201], v[76:77], v[58:59] op_sel:[1,0,0] op_sel_hi:[1,1,1]
v_pk_fma_f32 v[78:79], v[200:201], v[56:57], v[78:79] op_sel:[1,0,0] op_sel_hi:[1,1,1] neg_lo:[1,0,0] neg_hi:[1,0,0]
v_cvt_pk_bf16_f32 v116, v16, v18
v_cvt_pk_bf16_f32 v117, v56, v58
v_cvt_pk_bf16_f32 v118, v17, v19
v_cvt_pk_bf16_f32 v119, v57, v59
ds_write_b128 v9, v[116:119] offset:0
v_cvt_pk_bf16_f32 v120, v36, v38
v_cvt_pk_bf16_f32 v121, v76, v78
v_cvt_pk_bf16_f32 v122, v37, v39
v_cvt_pk_bf16_f32 v123, v77, v79
ds_write_b128 v9, v[120:123] offset:1024
ds_read_b64_tr_b16 v[132:133], v11 offset:0
ds_read_b64_tr_b16 v[134:135], v15 offset:256
ds_read_b64_tr_b16 v[136:137], v15 offset:0
ds_read_b64_tr_b16 v[138:139], v11 offset:256
s_waitcnt lgkmcnt(6)
v_mov_b32 v102, v101
v_fma_f32 v103, v206, v101, v167
v_fma_f32 v101, v206, v100, v166
v_fma_f32 v103, -v207, v100, v103
v_fma_f32 v101, v207, v102, v101
v_pk_fma_f32 v[20:21], v[204:205], v[100:101], v[20:21] op_sel_hi:[0,1,1]
v_pk_fma_f32 v[40:41], v[204:205], v[102:103], v[40:41] op_sel_hi:[0,1,1]
v_pk_fma_f32 v[20:21], v[204:205], v[102:103], v[20:21] op_sel:[1,0,0] op_sel_hi:[1,1,1]
v_pk_fma_f32 v[40:41], v[204:205], v[100:101], v[40:41] op_sel:[1,0,0] op_sel_hi:[1,1,1] neg_lo:[1,0,0] neg_hi:[1,0,0]
v_pk_fma_f32 v[22:23], v[204:205], v[20:21], v[22:23] op_sel_hi:[0,1,1]
v_pk_fma_f32 v[42:43], v[204:205], v[40:41], v[42:43] op_sel_hi:[0,1,1]
v_pk_fma_f32 v[22:23], v[204:205], v[40:41], v[22:23] op_sel:[1,0,0] op_sel_hi:[1,1,1]
v_pk_fma_f32 v[42:43], v[204:205], v[20:21], v[42:43] op_sel:[1,0,0] op_sel_hi:[1,1,1] neg_lo:[1,0,0] neg_hi:[1,0,0]
s_waitcnt lgkmcnt(0)
s_nop 0
buffer_store_dwordx4 v[132:135], v8, s[16:19], s54 offen offset:0 sc1
buffer_store_dwordx4 v[136:139], v8, s[16:19], s55 offen offset:0 sc1
v_pk_fma_f32 v[60:61], v[204:205], v[22:23], v[60:61] op_sel_hi:[0,1,1]
v_pk_fma_f32 v[80:81], v[204:205], v[42:43], v[80:81] op_sel_hi:[0,1,1]
v_pk_fma_f32 v[60:61], v[204:205], v[42:43], v[60:61] op_sel:[1,0,0] op_sel_hi:[1,1,1]
v_pk_fma_f32 v[80:81], v[204:205], v[22:23], v[80:81] op_sel:[1,0,0] op_sel_hi:[1,1,1] neg_lo:[1,0,0] neg_hi:[1,0,0]
v_pk_fma_f32 v[62:63], v[204:205], v[60:61], v[62:63] op_sel_hi:[0,1,1]
v_pk_fma_f32 v[82:83], v[204:205], v[80:81], v[82:83] op_sel_hi:[0,1,1]
v_pk_fma_f32 v[62:63], v[204:205], v[80:81], v[62:63] op_sel:[1,0,0] op_sel_hi:[1,1,1]
v_pk_fma_f32 v[82:83], v[204:205], v[60:61], v[82:83] op_sel:[1,0,0] op_sel_hi:[1,1,1] neg_lo:[1,0,0] neg_hi:[1,0,0]
v_cvt_pk_bf16_f32 v124, v20, v22
v_cvt_pk_bf16_f32 v125, v60, v62
v_cvt_pk_bf16_f32 v126, v21, v23
v_cvt_pk_bf16_f32 v127, v61, v63
ds_write_b128 v9, v[124:127] offset:0
v_cvt_pk_bf16_f32 v128, v40, v42
v_cvt_pk_bf16_f32 v129, v80, v82
v_cvt_pk_bf16_f32 v130, v41, v43
v_cvt_pk_bf16_f32 v131, v81, v83
ds_write_b128 v9, v[128:131] offset:1024
ds_read_b64_tr_b16 v[140:141], v11 offset:0
ds_read_b64_tr_b16 v[142:143], v15 offset:256
ds_read_b64_tr_b16 v[144:145], v15 offset:0
ds_read_b64_tr_b16 v[146:147], v11 offset:256
s_nop 0
v_mov_b32 v106, v105
v_fma_f32 v107, v210, v105, v169
v_fma_f32 v105, v210, v104, v168
v_fma_f32 v107, -v211, v104, v107
v_fma_f32 v105, v211, v106, v105
v_pk_fma_f32 v[24:25], v[208:209], v[104:105], v[24:25] op_sel_hi:[0,1,1]
v_pk_fma_f32 v[44:45], v[208:209], v[106:107], v[44:45] op_sel_hi:[0,1,1]
v_pk_fma_f32 v[24:25], v[208:209], v[106:107], v[24:25] op_sel:[1,0,0] op_sel_hi:[1,1,1]
v_pk_fma_f32 v[44:45], v[208:209], v[104:105], v[44:45] op_sel:[1,0,0] op_sel_hi:[1,1,1] neg_lo:[1,0,0] neg_hi:[1,0,0]
v_pk_fma_f32 v[26:27], v[208:209], v[24:25], v[26:27] op_sel_hi:[0,1,1]
v_pk_fma_f32 v[46:47], v[208:209], v[44:45], v[46:47] op_sel_hi:[0,1,1]
v_pk_fma_f32 v[26:27], v[208:209], v[44:45], v[26:27] op_sel:[1,0,0] op_sel_hi:[1,1,1]
v_pk_fma_f32 v[46:47], v[208:209], v[24:25], v[46:47] op_sel:[1,0,0] op_sel_hi:[1,1,1] neg_lo:[1,0,0] neg_hi:[1,0,0]
s_waitcnt lgkmcnt(0)
s_nop 0
buffer_store_dwordx4 v[140:143], v8, s[16:19], s54 offen offset:512 sc1
buffer_store_dwordx4 v[144:147], v8, s[16:19], s55 offen offset:512 sc1
v_pk_fma_f32 v[64:65], v[208:209], v[26:27], v[64:65] op_sel_hi:[0,1,1]
v_pk_fma_f32 v[84:85], v[208:209], v[46:47], v[84:85] op_sel_hi:[0,1,1]
v_pk_fma_f32 v[64:65], v[208:209], v[46:47], v[64:65] op_sel:[1,0,0] op_sel_hi:[1,1,1]
v_pk_fma_f32 v[84:85], v[208:209], v[26:27], v[84:85] op_sel:[1,0,0] op_sel_hi:[1,1,1] neg_lo:[1,0,0] neg_hi:[1,0,0]
v_pk_fma_f32 v[66:67], v[208:209], v[64:65], v[66:67] op_sel_hi:[0,1,1]
v_pk_fma_f32 v[86:87], v[208:209], v[84:85], v[86:87] op_sel_hi:[0,1,1]
v_pk_fma_f32 v[66:67], v[208:209], v[84:85], v[66:67] op_sel:[1,0,0] op_sel_hi:[1,1,1]
v_pk_fma_f32 v[86:87], v[208:209], v[64:65], v[86:87] op_sel:[1,0,0] op_sel_hi:[1,1,1] neg_lo:[1,0,0] neg_hi:[1,0,0]
v_cvt_pk_bf16_f32 v116, v24, v26
v_cvt_pk_bf16_f32 v117, v64, v66
v_cvt_pk_bf16_f32 v118, v25, v27
v_cvt_pk_bf16_f32 v119, v65, v67
ds_write_b128 v9, v[116:119] offset:0
v_cvt_pk_bf16_f32 v120, v44, v46
v_cvt_pk_bf16_f32 v121, v84, v86
v_cvt_pk_bf16_f32 v122, v45, v47
v_cvt_pk_bf16_f32 v123, v85, v87
ds_write_b128 v9, v[120:123] offset:1024
ds_read_b64_tr_b16 v[132:133], v11 offset:0
ds_read_b64_tr_b16 v[134:135], v15 offset:256
ds_read_b64_tr_b16 v[136:137], v15 offset:0
ds_read_b64_tr_b16 v[138:139], v11 offset:256
s_nop 0
v_mov_b32 v110, v109
v_fma_f32 v111, v214, v109, v171
v_fma_f32 v109, v214, v108, v170
v_fma_f32 v111, -v215, v108, v111
v_fma_f32 v109, v215, v110, v109
v_pk_fma_f32 v[28:29], v[212:213], v[108:109], v[28:29] op_sel_hi:[0,1,1]
v_pk_fma_f32 v[48:49], v[212:213], v[110:111], v[48:49] op_sel_hi:[0,1,1]
v_pk_fma_f32 v[28:29], v[212:213], v[110:111], v[28:29] op_sel:[1,0,0] op_sel_hi:[1,1,1]
v_pk_fma_f32 v[48:49], v[212:213], v[108:109], v[48:49] op_sel:[1,0,0] op_sel_hi:[1,1,1] neg_lo:[1,0,0] neg_hi:[1,0,0]
v_pk_fma_f32 v[30:31], v[212:213], v[28:29], v[30:31] op_sel_hi:[0,1,1]
v_pk_fma_f32 v[50:51], v[212:213], v[48:49], v[50:51] op_sel_hi:[0,1,1]
v_pk_fma_f32 v[30:31], v[212:213], v[48:49], v[30:31] op_sel:[1,0,0] op_sel_hi:[1,1,1]
v_pk_fma_f32 v[50:51], v[212:213], v[28:29], v[50:51] op_sel:[1,0,0] op_sel_hi:[1,1,1] neg_lo:[1,0,0] neg_hi:[1,0,0]
s_waitcnt lgkmcnt(0)
s_nop 0
buffer_store_dwordx4 v[132:135], v8, s[16:19], s54 offen offset:1024 sc1
buffer_store_dwordx4 v[136:139], v8, s[16:19], s55 offen offset:1024 sc1
v_pk_fma_f32 v[68:69], v[212:213], v[30:31], v[68:69] op_sel_hi:[0,1,1]
v_pk_fma_f32 v[88:89], v[212:213], v[50:51], v[88:89] op_sel_hi:[0,1,1]
v_pk_fma_f32 v[68:69], v[212:213], v[50:51], v[68:69] op_sel:[1,0,0] op_sel_hi:[1,1,1]
v_pk_fma_f32 v[88:89], v[212:213], v[30:31], v[88:89] op_sel:[1,0,0] op_sel_hi:[1,1,1] neg_lo:[1,0,0] neg_hi:[1,0,0]
v_pk_fma_f32 v[70:71], v[212:213], v[68:69], v[70:71] op_sel_hi:[0,1,1]
v_pk_fma_f32 v[90:91], v[212:213], v[88:89], v[90:91] op_sel_hi:[0,1,1]
v_pk_fma_f32 v[70:71], v[212:213], v[88:89], v[70:71] op_sel:[1,0,0] op_sel_hi:[1,1,1]
v_pk_fma_f32 v[90:91], v[212:213], v[68:69], v[90:91] op_sel:[1,0,0] op_sel_hi:[1,1,1] neg_lo:[1,0,0] neg_hi:[1,0,0]
v_cvt_pk_bf16_f32 v124, v28, v30
v_cvt_pk_bf16_f32 v125, v68, v70
v_cvt_pk_bf16_f32 v126, v29, v31
v_cvt_pk_bf16_f32 v127, v69, v71
ds_write_b128 v9, v[124:127] offset:0
v_cvt_pk_bf16_f32 v128, v48, v50
v_cvt_pk_bf16_f32 v129, v88, v90
v_cvt_pk_bf16_f32 v130, v49, v51
v_cvt_pk_bf16_f32 v131, v89, v91
ds_write_b128 v9, v[128:131] offset:1024
ds_read_b64_tr_b16 v[140:141], v11 offset:0
ds_read_b64_tr_b16 v[142:143], v15 offset:256
ds_read_b64_tr_b16 v[144:145], v15 offset:0
ds_read_b64_tr_b16 v[146:147], v11 offset:256
s_nop 0
v_mov_b32 v114, v113
v_fma_f32 v115, v218, v113, v173
v_fma_f32 v113, v218, v112, v172
v_fma_f32 v115, -v219, v112, v115
v_fma_f32 v113, v219, v114, v113
v_pk_fma_f32 v[32:33], v[216:217], v[112:113], v[32:33] op_sel_hi:[0,1,1]
v_pk_fma_f32 v[52:53], v[216:217], v[114:115], v[52:53] op_sel_hi:[0,1,1]
v_pk_fma_f32 v[32:33], v[216:217], v[114:115], v[32:33] op_sel:[1,0,0] op_sel_hi:[1,1,1]
v_pk_fma_f32 v[52:53], v[216:217], v[112:113], v[52:53] op_sel:[1,0,0] op_sel_hi:[1,1,1] neg_lo:[1,0,0] neg_hi:[1,0,0]
v_pk_fma_f32 v[34:35], v[216:217], v[32:33], v[34:35] op_sel_hi:[0,1,1]
v_pk_fma_f32 v[54:55], v[216:217], v[52:53], v[54:55] op_sel_hi:[0,1,1]
v_pk_fma_f32 v[34:35], v[216:217], v[52:53], v[34:35] op_sel:[1,0,0] op_sel_hi:[1,1,1]
v_pk_fma_f32 v[54:55], v[216:217], v[32:33], v[54:55] op_sel:[1,0,0] op_sel_hi:[1,1,1] neg_lo:[1,0,0] neg_hi:[1,0,0]
s_waitcnt lgkmcnt(0)
s_nop 0
buffer_store_dwordx4 v[140:143], v8, s[16:19], s54 offen offset:1536 sc1
buffer_store_dwordx4 v[144:147], v8, s[16:19], s55 offen offset:1536 sc1
v_pk_fma_f32 v[72:73], v[216:217], v[34:35], v[72:73] op_sel_hi:[0,1,1]
v_pk_fma_f32 v[92:93], v[216:217], v[54:55], v[92:93] op_sel_hi:[0,1,1]
v_pk_fma_f32 v[72:73], v[216:217], v[54:55], v[72:73] op_sel:[1,0,0] op_sel_hi:[1,1,1]
v_pk_fma_f32 v[92:93], v[216:217], v[34:35], v[92:93] op_sel:[1,0,0] op_sel_hi:[1,1,1] neg_lo:[1,0,0] neg_hi:[1,0,0]
v_pk_fma_f32 v[74:75], v[216:217], v[72:73], v[74:75] op_sel_hi:[0,1,1]
v_pk_fma_f32 v[94:95], v[216:217], v[92:93], v[94:95] op_sel_hi:[0,1,1]
v_pk_fma_f32 v[74:75], v[216:217], v[92:93], v[74:75] op_sel:[1,0,0] op_sel_hi:[1,1,1]
v_pk_fma_f32 v[94:95], v[216:217], v[72:73], v[94:95] op_sel:[1,0,0] op_sel_hi:[1,1,1] neg_lo:[1,0,0] neg_hi:[1,0,0]
v_cvt_pk_bf16_f32 v116, v32, v34
v_cvt_pk_bf16_f32 v117, v72, v74
v_cvt_pk_bf16_f32 v118, v33, v35
v_cvt_pk_bf16_f32 v119, v73, v75
ds_write_b128 v9, v[116:119] offset:0
v_cvt_pk_bf16_f32 v120, v52, v54
v_cvt_pk_bf16_f32 v121, v92, v94
v_cvt_pk_bf16_f32 v122, v53, v55
v_cvt_pk_bf16_f32 v123, v93, v95
ds_write_b128 v9, v[120:123] offset:1024
ds_read_b64_tr_b16 v[132:133], v11 offset:0
ds_read_b64_tr_b16 v[134:135], v15 offset:256
ds_read_b64_tr_b16 v[136:137], v15 offset:0
ds_read_b64_tr_b16 v[138:139], v11 offset:256
s_waitcnt lgkmcnt(0)
s_nop 0
buffer_store_dwordx4 v[132:135], v8, s[16:19], s54 offen offset:2048 sc1
buffer_store_dwordx4 v[136:139], v8, s[16:19], s55 offen offset:2048 sc1
s_mov_b32 s100, 0
s_waitcnt vmcnt(22)
L_g:
v_cmp_ne_u64 vcc, v[162:163], v[186:187]
s_add_u32 s100, s100, 1
s_cbranch_vccnz L_g_slow
L_g_ok:
s_bitcmp1_b32 s2, 0
s_cselect_b64 vcc, -1, 0
s_mov_b32 s97, 0xffff0000
v_cndmask_b32 v8, v160, v161, vcc
v_cndmask_b32 v9, v161, v160, vcc
s_add_u32 m0, s94, 0
s_nop 0
buffer_load_dwordx4 v238, s[12:15], s96 offen offset:0  lds
ds_bpermute_b32 v224, v174, v8 offset:0
ds_bpermute_b32 v225, v175, v8 offset:0
ds_bpermute_b32 v248, v176, v8 offset:0
ds_bpermute_b32 v249, v174, v8 offset:32
ds_bpermute_b32 v250, v175, v8 offset:32
ds_bpermute_b32 v251, v176, v8 offset:32
ds_bpermute_b32 v136, v174, v8 offset:64
ds_bpermute_b32 v137, v174, v9 offset:64
ds_bpermute_b32 v138, v175, v8 offset:64
ds_bpermute_b32 v139, v175, v9 offset:64
ds_bpermute_b32 v140, v176, v8 offset:64
ds_bpermute_b32 v141, v176, v9 offset:64
ds_bpermute_b32 v142, v174, v8 offset:96
ds_bpermute_b32 v143, v174, v9 offset:96
ds_bpermute_b32 v144, v175, v8 offset:96
ds_bpermute_b32 v145, v175, v9 offset:96
ds_bpermute_b32 v146, v176, v8 offset:96
ds_bpermute_b32 v147, v176, v9 offset:96
s_waitcnt vmcnt(11)
buffer_load_dwordx4 v239, s[12:15], s96 offen offset:1024  lds
v_lshlrev_b32 v44, 16, v148
v_and_b32 v45, s97, v148
v_lshlrev_b32 v46, 16, v149
v_and_b32 v47, s97, v149
v_lshlrev_b32 v48, 16, v150
v_and_b32 v49, s97, v150
v_lshlrev_b32 v50, 16, v151
v_and_b32 v51, s97, v151
v_lshlrev_b32 v52, 16, v152
v_and_b32 v53, s97, v152
v_lshlrev_b32 v54, 16, v153
v_and_b32 v55, s97, v153
v_lshlrev_b32 v56, 16, v154
v_and_b32 v57, s97, v154
v_lshlrev_b32 v58, 16, v155
v_and_b32 v59, s97, v155
v_lshlrev_b32 v60, 16, v156
v_and_b32 v61, s97, v156
v_lshlrev_b32 v62, 16, v157
v_and_b32 v63, s97, v157
buffer_load_dwordx4 v240, s[12:15], s96 offen offset:2048  lds
v_lshlrev_b32 v64, 16, v158
v_and_b32 v65, s97, v158
v_lshlrev_b32 v66, 16, v159
v_and_b32 v67, s97, v159
v_add_u32 v148, 40960, v192
v_add_u32 v149, 40960, v193
v_add_u32 v150, 40960, v189
v_and_b32 v2, 31, v1
v_lshlrev_b32 v152, 4, v2
s_mov_b32 s54, 0x7060500
s_mov_b32 s55, 0x7060501
s_mov_b32 s56, 0x7060502
s_mov_b32 s57, 0x7060503
s_mov_b32 s68, 0x0c0c0400
s_mov_b32 s69, 0x04000c0c
s_waitcnt lgkmcnt(0)
v_lshlrev_b32 v2, 16, v226
v_and_b32 v3, s97, v226
v_pk_mul_f32 v[4:5], v[2:3], v[44:45]
v_pk_mul_f32 v[6:7], v[2:3], v[48:49]
buffer_load_dwordx4 v241, s[12:15], s96 offen offset:3072  lds
v_cvt_pk_bf16_f32 v4, v4, v5
v_cvt_pk_bf16_f32 v6, v6, v7
v_and_b32 v5, s97, v4
v_lshlrev_b32 v4, 16, v4
v_and_b32 v7, s97, v6
v_lshlrev_b32 v6, 16, v6
v_pk_mul_f32 v[200:201], v[136:137], v[4:5] op_sel_hi:[0,1]
v_pk_fma_f32 v[200:201], v[136:137], v[6:7], v[200:201] op_sel:[1,0,0] op_sel_hi:[1,1,1]
v_lshlrev_b32 v2, 16, v227
v_and_b32 v3, s97, v227
v_pk_mul_f32 v[4:5], v[2:3], v[46:47]
v_pk_mul_f32 v[6:7], v[2:3], v[50:51]
v_cvt_pk_bf16_f32 v4, v4, v5
v_cvt_pk_bf16_f32 v6, v6, v7
v_and_b32 v5, s97, v4
v_lshlrev_b32 v4, 16, v4
v_and_b32 v7, s97, v6
v_lshlrev_b32 v6, 16, v6
v_pk_mul_f32 v[202:203], v[136:137], v[4:5] op_sel_hi:[0,1]
v_pk_fma_f32 v[202:203], v[136:137], v[6:7], v[202:203] op_sel:[1,0,0] op_sel_hi:[1,1,1]
s_add_u32 m0, s94, 4096
s_nop 0
buffer_load_dwordx4 v242, s[12:15], s96 offen offset:0  lds
v_lshlrev_b32 v2, 16, v228
v_and_b32 v3, s97, v228
v_pk_mul_f32 v[4:5], v[2:3], v[52:53]
v_pk_mul_f32 v[6:7], v[2:3], v[56:57]
v_cvt_pk_bf16_f32 v4, v4, v5
v_cvt_pk_bf16_f32 v6, v6, v7
v_and_b32 v5, s97, v4
v_lshlrev_b32 v4, 16, v4
v_and_b32 v7, s97, v6
v_lshlrev_b32 v6, 16, v6
v_pk_mul_f32 v[204:205], v[138:139], v[4:5] op_sel_hi:[0,1]
v_pk_fma_f32 v[204:205], v[138:139], v[6:7], v[204:205] op_sel:[1,0,0] op_sel_hi:[1,1,1]
v_lshlrev_b32 v2, 16, v229
v_and_b32 v3, s97, v229
v_pk_mul_f32 v[4:5], v[2:3], v[54:55]
v_pk_mul_f32 v[6:7], v[2:3], v[58:59]
v_cvt_pk_bf16_f32 v4, v4, v5
v_cvt_pk_bf16_f32 v6, v6, v7
v_and_b32 v5, s97, v4
v_lshlrev_b32 v4, 16, v4
buffer_load_dwordx4 v243, s[12:15], s96 offen offset:1024  lds
v_and_b32 v7, s97, v6
v_lshlrev_b32 v6, 16, v6
v_pk_mul_f32 v[206:207], v[138:139], v[4:5] op_sel_hi:[0,1]
v_pk_fma_f32 v[206:207], v[138:139], v[6:7], v[206:207] op_sel:[1,0,0] op_sel_hi:[1,1,1]
v_lshlrev_b32 v2, 16, v230
v_and_b32 v3, s97, v230
v_pk_mul_f32 v[4:5], v[2:3], v[60:61]
v_pk_mul_f32 v[6:7], v[2:3], v[64:65]
v_cvt_pk_bf16_f32 v4, v4, v5
v_cvt_pk_bf16_f32 v6, v6, v7
v_and_b32 v5, s97, v4
v_lshlrev_b32 v4, 16, v4
v_and_b32 v7, s97, v6
v_lshlrev_b32 v6, 16, v6
v_pk_mul_f32 v[208:209], v[140:141], v[4:5] op_sel_hi:[0,1]
v_pk_fma_f32 v[208:209], v[140:141], v[6:7], v[208:209] op_sel:[1,0,0] op_sel_hi:[1,1,1]
v_lshlrev_b32 v2, 16, v231
v_and_b32 v3, s97, v231
v_pk_mul_f32 v[4:5], v[2:3], v[62:63]
v_pk_mul_f32 v[6:7], v[2:3], v[66:67]
buffer_load_dwordx4 v244, s[12:15], s96 offen offset:2048  lds
v_cvt_pk_bf16_f32 v4, v4, v5
v_cvt_pk_bf16_f32 v6, v6, v7
v_and_b32 v5, s97, v4
v_lshlrev_b32 v4, 16, v4
v_and_b32 v7, s97, v6
v_lshlrev_b32 v6, 16, v6
v_pk_mul_f32 v[210:211], v[140:141], v[4:5] op_sel_hi:[0,1]
v_pk_fma_f32 v[210:211], v[140:141], v[6:7], v[210:211] op_sel:[1,0,0] op_sel_hi:[1,1,1]
v_lshlrev_b32 v2, 16, v232
v_and_b32 v3, s97, v232
v_pk_mul_f32 v[4:5], v[2:3], v[44:45]
v_pk_mul_f32 v[6:7], v[2:3], v[48:49]
v_cvt_pk_bf16_f32 v4, v4, v5
v_cvt_pk_bf16_f32 v6, v6, v7
v_and_b32 v5, s97, v4
v_lshlrev_b32 v4, 16, v4
v_and_b32 v7, s97, v6
v_lshlrev_b32 v6, 16, v6
v_pk_mul_f32 v[212:213], v[142:143], v[4:5] op_sel_hi:[0,1]
v_pk_fma_f32 v[212:213], v[142:143], v[6:7], v[212:213] op_sel:[1,0,0] op_sel_hi:[1,1,1]
buffer_load_dwordx4 v245, s[12:15], s96 offen offset:3072  lds
v_lshlrev_b32 v2, 16, v233
v_and_b32 v3, s97, v233
v_pk_mul_f32 v[4:5], v[2:3], v[46:47]
v_pk_mul_f32 v[6:7], v[2:3], v[50:51]
v_cvt_pk_bf16_f32 v4, v4, v5
v_cvt_pk_bf16_f32 v6, v6, v7
v_and_b32 v5, s97, v4
v_lshlrev_b32 v4, 16, v4
v_and_b32 v7, s97, v6
v_lshlrev_b32 v6, 16, v6
v_pk_mul_f32 v[214:215], v[142:143], v[4:5] op_sel_hi:[0,1]
v_pk_fma_f32 v[214:215], v[142:143], v[6:7], v[214:215] op_sel:[1,0,0] op_sel_hi:[1,1,1]
v_lshlrev_b32 v2, 16, v234
v_and_b32 v3, s97, v234
v_pk_mul_f32 v[4:5], v[2:3], v[52:53]
v_pk_mul_f32 v[6:7], v[2:3], v[56:57]
v_cvt_pk_bf16_f32 v4, v4, v5
v_cvt_pk_bf16_f32 v6, v6, v7
v_and_b32 v5, s97, v4
v_lshlrev_b32 v4, 16, v4
s_add_u32 m0, s94, 8192
s_nop 0
buffer_load_dwordx4 v246, s[12:15], s96 offen offset:0  lds
v_and_b32 v7, s97, v6
v_lshlrev_b32 v6, 16, v6
v_pk_mul_f32 v[216:217], v[144:145], v[4:5] op_sel_hi:[0,1]
v_pk_fma_f32 v[216:217], v[144:145], v[6:7], v[216:217] op_sel:[1,0,0] op_sel_hi:[1,1,1]
v_lshlrev_b32 v2, 16, v235
v_and_b32 v3, s97, v235
v_pk_mul_f32 v[4:5], v[2:3], v[54:55]
v_pk_mul_f32 v[6:7], v[2:3], v[58:59]
v_cvt_pk_bf16_f32 v4, v4, v5
v_cvt_pk_bf16_f32 v6, v6, v7
v_and_b32 v5, s97, v4
v_lshlrev_b32 v4, 16, v4
v_and_b32 v7, s97, v6
v_lshlrev_b32 v6, 16, v6
v_pk_mul_f32 v[218:219], v[144:145], v[4:5] op_sel_hi:[0,1]
v_pk_fma_f32 v[218:219], v[144:145], v[6:7], v[218:219] op_sel:[1,0,0] op_sel_hi:[1,1,1]
v_lshlrev_b32 v2, 16, v236
v_and_b32 v3, s97, v236
v_pk_mul_f32 v[4:5], v[2:3], v[60:61]
v_pk_mul_f32 v[6:7], v[2:3], v[64:65]
buffer_load_dwordx4 v247, s[12:15], s96 offen offset:1024  lds
s_add_u32 s96, s96, 128
s_cmp_eq_u32 s96, 640
s_cselect_b32 s96, 0, s96
v_cvt_pk_bf16_f32 v4, v4, v5
v_cvt_pk_bf16_f32 v6, v6, v7
v_and_b32 v5, s97, v4
v_lshlrev_b32 v4, 16, v4
v_and_b32 v7, s97, v6
v_lshlrev_b32 v6, 16, v6
v_pk_mul_f32 v[220:221], v[146:147], v[4:5] op_sel_hi:[0,1]
v_pk_fma_f32 v[220:221], v[146:147], v[6:7], v[220:221] op_sel:[1,0,0] op_sel_hi:[1,1,1]
v_lshlrev_b32 v2, 16, v237
v_and_b32 v3, s97, v237
v_pk_mul_f32 v[4:5], v[2:3], v[62:63]
v_pk_mul_f32 v[6:7], v[2:3], v[66:67]
v_cvt_pk_bf16_f32 v4, v4, v5
v_cvt_pk_bf16_f32 v6, v6, v7
v_and_b32 v5, s97, v4
v_lshlrev_b32 v4, 16, v4
v_and_b32 v7, s97, v6
v_lshlrev_b32 v6, 16, v6
v_pk_mul_f32 v[222:223], v[146:147], v[4:5] op_sel_hi:[0,1]
v_pk_fma_f32 v[222:223], v[146:147], v[6:7], v[222:223] op_sel:[1,0,0] op_sel_hi:[1,1,1]
s_waitcnt vmcnt(10)
s_barrier
buffer_store_dwordx2 v[186:187], v198, s[16:19], 0 offen sc1
s_add_u32 m0, s94, 81920
s_nop 0
buffer_load_dwordx4 v238, s[12:15], s96 offen offset:0  lds
buffer_load_dwordx4 v239, s[12:15], s96 offen offset:1024  lds
buffer_load_dwordx4 v240, s[12:15], s96 offen offset:2048  lds
buffer_load_dwordx4 v241, s[12:15], s96 offen offset:3072  lds
s_add_u32 m0, s94, 86016
s_nop 0
buffer_load_dwordx4 v242, s[12:15], s96 offen offset:0  lds
buffer_load_dwordx4 v243, s[12:15], s96 offen offset:1024  lds
buffer_load_dwordx4 v244, s[12:15], s96 offen offset:2048  lds
buffer_load_dwordx4 v245, s[12:15], s96 offen offset:3072  lds
s_add_u32 m0, s94, 90112
s_nop 0
buffer_load_dwordx4 v246, s[12:15], s96 offen offset:0  lds
buffer_load_dwordx4 v247, s[12:15], s96 offen offset:1024  lds
s_add_u32 s96, s96, 128
s_cmp_eq_u32 s96, 640
s_cselect_b32 s96, 0, s96
s_add_u32 m0, s94, 122880
s_nop 0
buffer_load_dwordx4 v238, s[12:15], s96 offen offset:0  lds
buffer_load_dwordx4 v239, s[12:15], s96 offen offset:1024  lds
buffer_load_dwordx4 v240, s[12:15], s96 offen offset:2048  lds
buffer_load_dwordx4 v241, s[12:15], s96 offen offset:3072  lds
s_add_u32 m0, s94, 126976
s_nop 0
buffer_load_dwordx4 v242, s[12:15], s96 offen offset:0  lds
buffer_load_dwordx4 v243, s[12:15], s96 offen offset:1024  lds
buffer_load_dwordx4 v244, s[12:15], s96 offen offset:2048  lds
buffer_load_dwordx4 v245, s[12:15], s96 offen offset:3072  lds
s_add_u32 m0, s94, 131072
s_nop 0
buffer_load_dwordx4 v246, s[12:15], s96 offen offset:0  lds
buffer_load_dwordx4 v247, s[12:15], s96 offen offset:1024  lds
s_add_u32 s96, s96, 128
s_cmp_eq_u32 s96, 640
s_cselect_b32 s96, 0, s96
s_waitcnt vmcnt(21)
ds_read_b128 a[80:83], v180 offset:0
ds_read_b128 a[84:87], v180 offset:2048
ds_read_b128 a[88:91], v180 offset:4096
ds_read_b128 a[92:95], v180 offset:6144
ds_read_b128 a[96:99], v180 offset:8192
ds_read_b128 a[100:103], v183 offset:0
ds_read_b128 a[104:107], v183 offset:2048
ds_read_b128 a[108:111], v183 offset:4096
ds_read_b128 a[112:115], v183 offset:6144
ds_read_b128 a[116:119], v183 offset:8192
s_waitcnt vmcnt(10)
ds_read_b128 a[120:123], v181 offset:0
ds_read_b128 a[124:127], v181 offset:2048
ds_read_b128 a[128:131], v181 offset:4096
ds_read_b128 a[132:135], v181 offset:6144
ds_read_b128 a[136:139], v181 offset:8192
ds_read_b128 a[140:143], v184 offset:0
ds_read_b128 a[144:147], v184 offset:2048
ds_read_b128 a[148:151], v184 offset:4096
ds_read_b128 a[152:155], v184 offset:6144
ds_read_b128 a[156:159], v184 offset:8192
s_waitcnt vmcnt(0)
ds_read_b128 a[160:163], v182 offset:0
ds_read_b128 a[164:167], v182 offset:2048
ds_read_b128 a[168:171], v182 offset:4096
ds_read_b128 a[172:175], v182 offset:6144
ds_read_b128 a[176:179], v182 offset:8192
ds_read_b128 a[180:183], v185 offset:0
ds_read_b128 a[184:187], v185 offset:2048
ds_read_b128 a[188:191], v185 offset:4096
ds_read_b128 a[192:195], v185 offset:6144
ds_read_b128 a[196:199], v185 offset:8192
s_cmp_lg_u32 s3, 0
s_cbranch_scc1 L_f_done
s_mov_b32 s100, 0
s_mov_b64 exec, 0x1ffff
L_f:
buffer_load_dwordx2 v[16:17], v255, s[16:19], 0 offen sc1
s_waitcnt vmcnt(0)
v_cmp_ne_u64 vcc, v[16:17], v[186:187]
s_add_u32 s100, s100, 1
s_cbranch_vccz L_f_ok
s_cmp_gt_u32 s100, 65536
s_cbranch_scc0 L_f
L_f_ok:
s_mov_b64 exec, -1
L_f_done:
s_barrier
buffer_load_dwordx4 v[16:19], v190, s[16:19], s44 offen offset:0 sc1
buffer_load_dwordx4 v[20:23], v190, s[16:19], s44 offen offset:1024 sc1
buffer_load_dwordx4 v[24:27], v190, s[16:19], s45 offen offset:0 sc1
buffer_load_dwordx4 v[28:31], v190, s[16:19], s45 offen offset:1024 sc1
buffer_load_dwordx4 v[32:35], v190, s[16:19], s46 offen offset:0 sc1
buffer_load_dwordx4 v[36:39], v190, s[16:19], s46 offen offset:1024 sc1
buffer_load_dwordx4 v[40:43], v190, s[16:19], s47 offen offset:0 sc1
buffer_load_dwordx4 v[44:47], v190, s[16:19], s47 offen offset:1024 sc1
buffer_load_dwordx4 v[48:51], v190, s[16:19], s48 offen offset:0 sc1
buffer_load_dwordx4 v[52:55], v190, s[16:19], s48 offen offset:1024 sc1
v_add_u32 v190, s59, v199
buffer_load_dwordx4 v[56:59], v190, s[16:19], s44 offen offset:0 sc1
buffer_load_dwordx4 v[60:63], v190, s[16:19], s44 offen offset:1024 sc1
buffer_load_dwordx4 v[64:67], v190, s[16:19], s45 offen offset:0 sc1
buffer_load_dwordx4 v[68:71], v190, s[16:19], s45 offen offset:1024 sc1
buffer_load_dwordx4 v[72:75], v190, s[16:19], s46 offen offset:0 sc1
buffer_load_dwordx4 v[76:79], v190, s[16:19], s46 offen offset:1024 sc1
buffer_load_dwordx4 v[80:83], v190, s[16:19], s47 offen offset:0 sc1
buffer_load_dwordx4 v[84:87], v190, s[16:19], s47 offen offset:1024 sc1
buffer_load_dwordx4 v[88:91], v190, s[16:19], s48 offen offset:0 sc1
buffer_load_dwordx4 v[92:95], v190, s[16:19], s48 offen offset:1024 sc1
v_add_u32 v190, s60, v199
s_mov_b32 s100, 0
s_waitcnt vmcnt(19) lgkmcnt(0)
v_mfma_f32_16x16x32_bf16 v[96:99], a[0:3], v[16:19], 0
v_mfma_f32_16x16x32_bf16 v[100:103], a[4:7], v[16:19], 0
v_mfma_f32_16x16x32_bf16 v[104:107], a[8:11], v[16:19], 0
v_mfma_f32_16x16x32_bf16 v[108:111], a[12:15], v[16:19], 0
v_mfma_f32_16x16x32_bf16 v[112:115], a[16:19], v[16:19], 0
s_waitcnt vmcnt(18)
v_mfma_f32_16x16x32_bf16 v[96:99], a[20:23], v[20:23], v[96:99]
buffer_load_dwordx4 v[16:19], v190, s[16:19], s44 offen offset:0 sc1
v_mfma_f32_16x16x32_bf16 v[100:103], a[24:27], v[20:23], v[100:103]
v_mfma_f32_16x16x32_bf16 v[104:107], a[28:31], v[20:23], v[104:107]
v_mfma_f32_16x16x32_bf16 v[108:111], a[32:35], v[20:23], v[108:111]
v_mfma_f32_16x16x32_bf16 v[112:115], a[36:39], v[20:23], v[112:115]
s_waitcnt vmcnt(18)
v_mfma_f32_16x16x32_bf16 v[96:99], a[40:43], v[24:27], v[96:99]
buffer_load_dwordx4 v[20:23], v190, s[16:19], s44 offen offset:1024 sc1
v_mfma_f32_16x16x32_bf16 v[100:103], a[44:47], v[24:27], v[100:103]
v_mfma_f32_16x16x32_bf16 v[104:107], a[48:51], v[24:27], v[104:107]
v_mfma_f32_16x16x32_bf16 v[108:111], a[52:55], v[24:27], v[108:111]
v_mfma_f32_16x16x32_bf16 v[112:115], a[56:59], v[24:27], v[112:115]
s_waitcnt vmcnt(18)
v_mfma_f32_16x16x32_bf16 v[96:99], a[60:63], v[28:31], v[96:99]
buffer_load_dwordx4 v[24:27], v190, s[16:19], s45 offen offset:0 sc1
v_mfma_f32_16x16x32_bf16 v[100:103], a[64:67], v[28:31], v[100:103]
v_mfma_f32_16x16x32_bf16 v[104:107], a[68:71], v[28:31], v[104:107]
v_mfma_f32_16x16x32_bf16 v[108:111], a[72:75], v[28:31], v[108:111]
v_mfma_f32_16x16x32_bf16 v[112:115], a[76:79], v[28:31], v[112:115]
s_waitcnt vmcnt(18)
v_mfma_f32_16x16x32_bf16 v[96:99], a[80:83], v[32:35], v[96:99]
buffer_load_dwordx4 v[28:31], v190, s[16:19], s45 offen offset:1024 sc1
v_mfma_f32_16x16x32_bf16 v[100:103], a[84:87], v[32:35], v[100:103]
v_mfma_f32_16x16x32_bf16 v[104:107], a[88:91], v[32:35], v[104:107]
v_mfma_f32_16x16x32_bf16 v[108:111], a[92:95], v[32:35], v[108:111]
v_mfma_f32_16x16x32_bf16 v[112:115], a[96:99], v[32:35], v[112:115]
s_waitcnt vmcnt(18)
v_mfma_f32_16x16x32_bf16 v[96:99], a[100:103], v[36:39], v[96:99]
buffer_load_dwordx4 v[32:35], v190, s[16:19], s46 offen offset:0 sc1
v_mfma_f32_16x16x32_bf16 v[100:103], a[104:107], v[36:39], v[100:103]
v_mfma_f32_16x16x32_bf16 v[104:107], a[108:111], v[36:39], v[104:107]
v_mfma_f32_16x16x32_bf16 v[108:111], a[112:115], v[36:39], v[108:111]
v_mfma_f32_16x16x32_bf16 v[112:115], a[116:119], v[36:39], v[112:115]
s_waitcnt vmcnt(18)
v_mfma_f32_16x16x32_bf16 v[96:99], a[120:123], v[40:43], v[96:99]
buffer_load_dwordx4 v[36:39], v190, s[16:19], s46 offen offset:1024 sc1
v_mfma_f32_16x16x32_bf16 v[100:103], a[124:127], v[40:43], v[100:103]
v_mfma_f32_16x16x32_bf16 v[104:107], a[128:131], v[40:43], v[104:107]
v_mfma_f32_16x16x32_bf16 v[108:111], a[132:135], v[40:43], v[108:111]
v_mfma_f32_16x16x32_bf16 v[112:115], a[136:139], v[40:43], v[112:115]
s_waitcnt vmcnt(18)
v_mfma_f32_16x16x32_bf16 v[96:99], a[140:143], v[44:47], v[96:99]
buffer_load_dwordx4 v[40:43], v190, s[16:19], s47 offen offset:0 sc1
v_mfma_f32_16x16x32_bf16 v[100:103], a[144:147], v[44:47], v[100:103]
v_mfma_f32_16x16x32_bf16 v[104:107], a[148:151], v[44:47], v[104:107]
v_mfma_f32_16x16x32_bf16 v[108:111], a[152:155], v[44:47], v[108:111]
v_mfma_f32_16x16x32_bf16 v[112:115], a[156:159], v[44:47], v[112:115]
s_waitcnt vmcnt(18)
v_mfma_f32_16x16x32_bf16 v[96:99], a[160:163], v[48:51], v[96:99]
buffer_load_dwordx4 v[44:47], v190, s[16:19], s47 offen offset:1024 sc1
v_mfma_f32_16x16x32_bf16 v[100:103], a[164:167], v[48:51], v[100:103]
v_mfma_f32_16x16x32_bf16 v[104:107], a[168:171], v[48:51], v[104:107]
v_mfma_f32_16x16x32_bf16 v[108:111], a[172:175], v[48:51], v[108:111]
v_mfma_f32_16x16x32_bf16 v[112:115], a[176:179], v[48:51], v[112:115]
s_waitcnt vmcnt(18)
v_mfma_f32_16x16x32_bf16 v[96:99], a[180:183], v[52:55], v[96:99]
buffer_load_dwordx4 v[48:51], v190, s[16:19], s48 offen offset:0 sc1
v_mfma_f32_16x16x32_bf16 v[100:103], a[184:187], v[52:55], v[100:103]
v_mfma_f32_16x16x32_bf16 v[104:107], a[188:191], v[52:55], v[104:107]
v_mfma_f32_16x16x32_bf16 v[108:111], a[192:195], v[52:55], v[108:111]
v_mfma_f32_16x16x32_bf16 v[112:115], a[196:199], v[52:55], v[112:115]
s_waitcnt vmcnt(18)
v_mfma_f32_16x16x32_bf16 v[116:119], a[0:3], v[56:59], 0
buffer_load_dwordx4 v[52:55], v190, s[16:19], s48 offen offset:1024 sc1
v_mfma_f32_16x16x32_bf16 v[120:123], a[4:7], v[56:59], 0
v_add_u32 v190, s61, v199
v_mfma_f32_16x16x32_bf16 v[124:127], a[8:11], v[56:59], 0
v_mfma_f32_16x16x32_bf16 v[128:131], a[12:15], v[56:59], 0
ds_write_b64 v191, v[96:97] offset:0
v_mfma_f32_16x16x32_bf16 v[132:135], a[16:19], v[56:59], 0
s_waitcnt vmcnt(18)
v_mfma_f32_16x16x32_bf16 v[116:119], a[20:23], v[60:63], v[116:119]
buffer_load_dwordx4 v[56:59], v190, s[16:19], s44 offen offset:0 sc1
v_mfma_f32_16x16x32_bf16 v[120:123], a[24:27], v[60:63], v[120:123]
ds_write_b64 v191, v[98:99] offset:8
v_mfma_f32_16x16x32_bf16 v[124:127], a[28:31], v[60:63], v[124:127]
v_mfma_f32_16x16x32_bf16 v[128:131], a[32:35], v[60:63], v[128:131]
ds_write_b64 v191, v[100:101] offset:64
v_mfma_f32_16x16x32_bf16 v[132:135], a[36:39], v[60:63], v[132:135]
s_waitcnt vmcnt(18)
v_mfma_f32_16x16x32_bf16 v[116:119], a[40:43], v[64:67], v[116:119]
buffer_load_dwordx4 v[60:63], v190, s[16:19], s44 offen offset:1024 sc1
v_mfma_f32_16x16x32_bf16 v[120:123], a[44:47], v[64:67], v[120:123]
ds_write_b64 v191, v[102:103] offset:72
v_mfma_f32_16x16x32_bf16 v[124:127], a[48:51], v[64:67], v[124:127]
v_mfma_f32_16x16x32_bf16 v[128:131], a[52:55], v[64:67], v[128:131]
ds_write_b64 v191, v[104:105] offset:128
v_mfma_f32_16x16x32_bf16 v[132:135], a[56:59], v[64:67], v[132:135]
s_waitcnt vmcnt(18)
v_mfma_f32_16x16x32_bf16 v[116:119], a[60:63], v[68:71], v[116:119]
buffer_load_dwordx4 v[64:67], v190, s[16:19], s45 offen offset:0 sc1
v_mfma_f32_16x16x32_bf16 v[120:123], a[64:67], v[68:71], v[120:123]
ds_write_b64 v191, v[106:107] offset:136
v_mfma_f32_16x16x32_bf16 v[124:127], a[68:71], v[68:71], v[124:127]
v_mfma_f32_16x16x32_bf16 v[128:131], a[72:75], v[68:71], v[128:131]
ds_write_b64 v191, v[108:109] offset:192
v_mfma_f32_16x16x32_bf16 v[132:135], a[76:79], v[68:71], v[132:135]
s_waitcnt vmcnt(18)
v_mfma_f32_16x16x32_bf16 v[116:119], a[80:83], v[72:75], v[116:119]
buffer_load_dwordx4 v[68:71], v190, s[16:19], s45 offen offset:1024 sc1
v_mfma_f32_16x16x32_bf16 v[120:123], a[84:87], v[72:75], v[120:123]
ds_write_b64 v191, v[110:111] offset:200
v_mfma_f32_16x16x32_bf16 v[124:127], a[88:91], v[72:75], v[124:127]
v_mfma_f32_16x16x32_bf16 v[128:131], a[92:95], v[72:75], v[128:131]
ds_write_b64 v191, v[112:113] offset:256
v_mfma_f32_16x16x32_bf16 v[132:135], a[96:99], v[72:75], v[132:135]
s_waitcnt vmcnt(18)
v_mfma_f32_16x16x32_bf16 v[116:119], a[100:103], v[76:79], v[116:119]
buffer_load_dwordx4 v[72:75], v190, s[16:19], s46 offen offset:0 sc1
v_mfma_f32_16x16x32_bf16 v[120:123], a[104:107], v[76:79], v[120:123]
ds_write_b64 v191, v[114:115] offset:264
v_mfma_f32_16x16x32_bf16 v[124:127], a[108:111], v[76:79], v[124:127]
v_mfma_f32_16x16x32_bf16 v[128:131], a[112:115], v[76:79], v[128:131]
v_mfma_f32_16x16x32_bf16 v[132:135], a[116:119], v[76:79], v[132:135]
s_waitcnt vmcnt(18)
v_mfma_f32_16x16x32_bf16 v[116:119], a[120:123], v[80:83], v[116:119]
buffer_load_dwordx4 v[76:79], v190, s[16:19], s46 offen offset:1024 sc1
v_mfma_f32_16x16x32_bf16 v[120:123], a[124:127], v[80:83], v[120:123]
v_mfma_f32_16x16x32_bf16 v[124:127], a[128:131], v[80:83], v[124:127]
v_mfma_f32_16x16x32_bf16 v[128:131], a[132:135], v[80:83], v[128:131]
v_mfma_f32_16x16x32_bf16 v[132:135], a[136:139], v[80:83], v[132:135]
s_waitcnt vmcnt(18)
v_mfma_f32_16x16x32_bf16 v[116:119], a[140:143], v[84:87], v[116:119]
buffer_load_dwordx4 v[80:83], v190, s[16:19], s47 offen offset:0 sc1
v_mfma_f32_16x16x32_bf16 v[120:123], a[144:147], v[84:87], v[120:123]
v_mfma_f32_16x16x32_bf16 v[124:127], a[148:151], v[84:87], v[124:127]
v_mfma_f32_16x16x32_bf16 v[128:131], a[152:155], v[84:87], v[128:131]
v_mfma_f32_16x16x32_bf16 v[132:135], a[156:159], v[84:87], v[132:135]
s_waitcnt vmcnt(18)
v_mfma_f32_16x16x32_bf16 v[116:119], a[160:163], v[88:91], v[116:119]
buffer_load_dwordx4 v[84:87], v190, s[16:19], s47 offen offset:1024 sc1
v_mfma_f32_16x16x32_bf16 v[120:123], a[164:167], v[88:91], v[120:123]
v_mfma_f32_16x16x32_bf16 v[124:127], a[168:171], v[88:91], v[124:127]
v_mfma_f32_16x16x32_bf16 v[128:131], a[172:175], v[88:91], v[128:131]
v_mfma_f32_16x16x32_bf16 v[132:135], a[176:179], v[88:91], v[132:135]
s_waitcnt vmcnt(18)
v_mfma_f32_16x16x32_bf16 v[116:119], a[180:183], v[92:95], v[116:119]
buffer_load_dwordx4 v[88:91], v190, s[16:19], s48 offen offset:0 sc1
v_mfma_f32_16x16x32_bf16 v[120:123], a[184:187], v[92:95], v[120:123]
v_mfma_f32_16x16x32_bf16 v[124:127], a[188:191], v[92:95], v[124:127]
v_mfma_f32_16x16x32_bf16 v[128:131], a[192:195], v[92:95], v[128:131]
v_mfma_f32_16x16x32_bf16 v[132:135], a[196:199], v[92:95], v[132:135]
s_waitcnt vmcnt(17)
v_mfma_f32_16x16x32_bf16 v[96:99], a[0:3], v[16:19], 0
buffer_load_dwordx4 v[92:95], v190, s[16:19], s48 offen offset:1024 sc1
v_mfma_f32_16x16x32_bf16 v[100:103], a[4:7], v[16:19], 0
v_add_u32 v190, s62, v199
v_mfma_f32_16x16x32_bf16 v[104:107], a[8:11], v[16:19], 0
v_mfma_f32_16x16x32_bf16 v[108:111], a[12:15], v[16:19], 0
ds_write_b64 v191, v[116:117] offset:5120
v_mfma_f32_16x16x32_bf16 v[112:115], a[16:19], v[16:19], 0
buffer_load_dwordx4 v[16:19], v190, s[16:19], s44 offen offset:0 sc1
v_mfma_f32_16x16x32_bf16 v[96:99], a[20:23], v[20:23], v[96:99]
ds_write_b64 v191, v[118:119] offset:5128
v_mfma_f32_16x16x32_bf16 v[100:103], a[24:27], v[20:23], v[100:103]
ds_write_b64 v191, v[120:121] offset:5184
v_mfma_f32_16x16x32_bf16 v[104:107], a[28:31], v[20:23], v[104:107]
ds_write_b64 v191, v[122:123] offset:5192
v_mfma_f32_16x16x32_bf16 v[108:111], a[32:35], v[20:23], v[108:111]
ds_write_b64 v191, v[124:125] offset:5248
v_mfma_f32_16x16x32_bf16 v[112:115], a[36:39], v[20:23], v[112:115]
ds_write_b64 v191, v[126:127] offset:5256
s_waitcnt vmcnt(17)
v_mfma_f32_16x16x32_bf16 v[96:99], a[40:43], v[24:27], v[96:99]
buffer_load_dwordx4 v[20:23], v190, s[16:19], s44 offen offset:1024 sc1
v_mfma_f32_16x16x32_bf16 v[100:103], a[44:47], v[24:27], v[100:103]
ds_write_b64 v191, v[128:129] offset:5312
v_mfma_f32_16x16x32_bf16 v[104:107], a[48:51], v[24:27], v[104:107]
ds_write_b64 v191, v[130:131] offset:5320
v_mfma_f32_16x16x32_bf16 v[108:111], a[52:55], v[24:27], v[108:111]
ds_write_b64 v191, v[132:133] offset:5376
v_mfma_f32_16x16x32_bf16 v[112:115], a[56:59], v[24:27], v[112:115]
buffer_load_dwordx4 v[24:27], v190, s[16:19], s45 offen offset:0 sc1
v_mfma_f32_16x16x32_bf16 v[96:99], a[60:63], v[28:31], v[96:99]
ds_write_b64 v191, v[134:135] offset:5384
v_mfma_f32_16x16x32_bf16 v[100:103], a[64:67], v[28:31], v[100:103]
v_mfma_f32_16x16x32_bf16 v[104:107], a[68:71], v[28:31], v[104:107]
v_mfma_f32_16x16x32_bf16 v[108:111], a[72:75], v[28:31], v[108:111]
v_mfma_f32_16x16x32_bf16 v[112:115], a[76:79], v[28:31], v[112:115]
s_waitcnt vmcnt(17)
v_mfma_f32_16x16x32_bf16 v[96:99], a[80:83], v[32:35], v[96:99]
buffer_load_dwordx4 v[28:31], v190, s[16:19], s45 offen offset:1024 sc1
v_mfma_f32_16x16x32_bf16 v[100:103], a[84:87], v[32:35], v[100:103]
s_waitcnt lgkmcnt(0)
s_barrier
v_mfma_f32_16x16x32_bf16 v[104:107], a[88:91], v[32:35], v[104:107]
ds_read_b128 v[232:235], v192 offset:0
v_mfma_f32_16x16x32_bf16 v[108:111], a[92:95], v[32:35], v[108:111]
ds_read_b128 v[236:239], v192 offset:10240
v_mfma_f32_16x16x32_bf16 v[112:115], a[96:99], v[32:35], v[112:115]
buffer_load_dwordx4 v[32:35], v190, s[16:19], s46 offen offset:0 sc1
v_mfma_f32_16x16x32_bf16 v[96:99], a[100:103], v[36:39], v[96:99]
ds_read_b128 v[240:243], v192 offset:20480
v_mfma_f32_16x16x32_bf16 v[100:103], a[104:107], v[36:39], v[100:103]
ds_read_b128 v[244:247], v192 offset:30720
v_mfma_f32_16x16x32_bf16 v[104:107], a[108:111], v[36:39], v[104:107]
ds_read_b128 v[156:159], v193 offset:0
v_mfma_f32_16x16x32_bf16 v[108:111], a[112:115], v[36:39], v[108:111]
ds_read_b128 v[160:163], v193 offset:10240
v_mfma_f32_16x16x32_bf16 v[112:115], a[116:119], v[36:39], v[112:115]
ds_read_b128 v[164:167], v193 offset:20480
s_waitcnt vmcnt(17)
v_mfma_f32_16x16x32_bf16 v[96:99], a[120:123], v[40:43], v[96:99]
buffer_load_dwordx4 v[36:39], v190, s[16:19], s46 offen offset:1024 sc1
v_mfma_f32_16x16x32_bf16 v[100:103], a[124:127], v[40:43], v[100:103]
ds_read_b128 v[168:171], v193 offset:30720
v_mfma_f32_16x16x32_bf16 v[104:107], a[128:131], v[40:43], v[104:107]
v_mfma_f32_16x16x32_bf16 v[108:111], a[132:135], v[40:43], v[108:111]
s_waitcnt lgkmcnt(4)
v_add_f32 v232, v232, v236
v_mfma_f32_16x16x32_bf16 v[112:115], a[136:139], v[40:43], v[112:115]
buffer_load_dwordx4 v[40:43], v190, s[16:19], s47 offen offset:0 sc1
v_mfma_f32_16x16x32_bf16 v[96:99], a[140:143], v[44:47], v[96:99]
v_add_f32 v233, v233, v237
v_add_f32 v234, v234, v238
v_mfma_f32_16x16x32_bf16 v[100:103], a[144:147], v[44:47], v[100:103]
v_add_f32 v235, v235, v239
v_add_f32 v240, v240, v244
v_mfma_f32_16x16x32_bf16 v[104:107], a[148:151], v[44:47], v[104:107]
v_add_f32 v241, v241, v245
v_add_f32 v242, v242, v246
v_mfma_f32_16x16x32_bf16 v[108:111], a[152:155], v[44:47], v[108:111]
v_add_f32 v243, v243, v247
v_add_f32 v232, v232, v240
v_mfma_f32_16x16x32_bf16 v[112:115], a[156:159], v[44:47], v[112:115]
v_add_f32 v233, v233, v241
s_waitcnt vmcnt(17)
v_mfma_f32_16x16x32_bf16 v[96:99], a[160:163], v[48:51], v[96:99]
buffer_load_dwordx4 v[44:47], v190, s[16:19], s47 offen offset:1024 sc1
v_mfma_f32_16x16x32_bf16 v[100:103], a[164:167], v[48:51], v[100:103]
v_add_f32 v234, v234, v242
v_add_f32 v235, v235, v243
v_mfma_f32_16x16x32_bf16 v[104:107], a[168:171], v[48:51], v[104:107]
v_mul_f32 v236, v224, v232
v_mul_f32 v237, v224, v233
v_mfma_f32_16x16x32_bf16 v[108:111], a[172:175], v[48:51], v[108:111]
v_mul_f32 v238, v224, v234
v_mul_f32 v239, v224, v235
v_mfma_f32_16x16x32_bf16 v[112:115], a[176:179], v[48:51], v[112:115]
buffer_load_dwordx4 v[48:51], v190, s[16:19], s48 offen offset:0 sc1
v_mfma_f32_16x16x32_bf16 v[96:99], a[180:183], v[52:55], v[96:99]
v_perm_b32 v236, v236, v186, s54
v_perm_b32 v237, v237, v186, s55
v_mfma_f32_16x16x32_bf16 v[100:103], a[184:187], v[52:55], v[100:103]
v_perm_b32 v238, v238, v186, s56
v_perm_b32 v239, v239, v186, s57
v_mfma_f32_16x16x32_bf16 v[104:107], a[188:191], v[52:55], v[104:107]
buffer_store_dwordx4 v[236:239], v178, s[16:19], s49 offen offset:0 sc1
v_mfma_f32_16x16x32_bf16 v[108:111], a[192:195], v[52:55], v[108:111]
ds_read_b128 v[232:235], v189 offset:0
s_waitcnt lgkmcnt(1)
v_mfma_f32_16x16x32_bf16 v[112:115], a[196:199], v[52:55], v[112:115]
ds_read_b128 v[236:239], v189 offset:10240
s_waitcnt vmcnt(18)
v_mfma_f32_16x16x32_bf16 v[116:119], a[0:3], v[56:59], 0
buffer_load_dwordx4 v[52:55], v190, s[16:19], s48 offen offset:1024 sc1
v_mfma_f32_16x16x32_bf16 v[120:123], a[4:7], v[56:59], 0
v_add_u32 v190, s63, v199
ds_read_b128 v[240:243], v189 offset:20480
v_mfma_f32_16x16x32_bf16 v[124:127], a[8:11], v[56:59], 0
ds_read_b128 v[244:247], v189 offset:30720
v_add_f32 v156, v156, v160
v_mfma_f32_16x16x32_bf16 v[128:131], a[12:15], v[56:59], 0
ds_write_b64 v191, v[96:97] offset:40960
v_add_f32 v157, v157, v161
v_mfma_f32_16x16x32_bf16 v[132:135], a[16:19], v[56:59], 0
buffer_load_dwordx4 v[56:59], v190, s[16:19], s44 offen offset:0 sc1
v_mfma_f32_16x16x32_bf16 v[116:119], a[20:23], v[60:63], v[116:119]
ds_write_b64 v191, v[98:99] offset:40968
v_add_f32 v158, v158, v162
v_mfma_f32_16x16x32_bf16 v[120:123], a[24:27], v[60:63], v[120:123]
v_add_f32 v159, v159, v163
v_add_f32 v164, v164, v168
v_mfma_f32_16x16x32_bf16 v[124:127], a[28:31], v[60:63], v[124:127]
ds_write_b64 v191, v[100:101] offset:41024
v_add_f32 v165, v165, v169
v_mfma_f32_16x16x32_bf16 v[128:131], a[32:35], v[60:63], v[128:131]
v_add_f32 v166, v166, v170
v_add_f32 v167, v167, v171
v_mfma_f32_16x16x32_bf16 v[132:135], a[36:39], v[60:63], v[132:135]
ds_write_b64 v191, v[102:103] offset:41032
s_waitcnt vmcnt(18)
v_mfma_f32_16x16x32_bf16 v[116:119], a[40:43], v[64:67], v[116:119]
buffer_load_dwordx4 v[60:63], v190, s[16:19], s44 offen offset:1024 sc1
v_mfma_f32_16x16x32_bf16 v[120:123], a[44:47], v[64:67], v[120:123]
ds_write_b64 v191, v[104:105] offset:41088
v_add_f32 v156, v156, v164
v_mfma_f32_16x16x32_bf16 v[124:127], a[48:51], v[64:67], v[124:127]
v_add_f32 v157, v157, v165
v_add_f32 v158, v158, v166
v_mfma_f32_16x16x32_bf16 v[128:131], a[52:55], v[64:67], v[128:131]
ds_write_b64 v191, v[106:107] offset:41096
v_add_f32 v159, v159, v167
v_mfma_f32_16x16x32_bf16 v[132:135], a[56:59], v[64:67], v[132:135]
buffer_load_dwordx4 v[64:67], v190, s[16:19], s45 offen offset:0 sc1
v_mfma_f32_16x16x32_bf16 v[116:119], a[60:63], v[68:71], v[116:119]
ds_write_b64 v191, v[108:109] offset:41152
v_mul_f32 v160, v225, v156
v_mfma_f32_16x16x32_bf16 v[120:123], a[64:67], v[68:71], v[120:123]
v_mul_f32 v161, v225, v157
v_mul_f32 v162, v225, v158
v_mfma_f32_16x16x32_bf16 v[124:127], a[68:71], v[68:71], v[124:127]
ds_write_b64 v191, v[110:111] offset:41160
v_mul_f32 v163, v225, v159
v_mfma_f32_16x16x32_bf16 v[128:131], a[72:75], v[68:71], v[128:131]
v_perm_b32 v160, v160, v186, s54
v_perm_b32 v161, v161, v186, s55
v_mfma_f32_16x16x32_bf16 v[132:135], a[76:79], v[68:71], v[132:135]
ds_write_b64 v191, v[112:113] offset:41216
s_waitcnt vmcnt(18)
v_mfma_f32_16x16x32_bf16 v[116:119], a[80:83], v[72:75], v[116:119]
buffer_load_dwordx4 v[68:71], v190, s[16:19], s45 offen offset:1024 sc1
v_mfma_f32_16x16x32_bf16 v[120:123], a[84:87], v[72:75], v[120:123]
ds_write_b64 v191, v[114:115] offset:41224
v_perm_b32 v162, v162, v186, s56
v_mfma_f32_16x16x32_bf16 v[124:127], a[88:91], v[72:75], v[124:127]
v_perm_b32 v163, v163, v186, s57
v_mfma_f32_16x16x32_bf16 v[128:131], a[92:95], v[72:75], v[128:131]
buffer_store_dwordx4 v[160:163], v178, s[16:19], s49 offen offset:1024 sc1
v_mfma_f32_16x16x32_bf16 v[132:135], a[96:99], v[72:75], v[132:135]
buffer_load_dwordx4 v[72:75], v190, s[16:19], s46 offen offset:0 sc1
v_mfma_f32_16x16x32_bf16 v[116:119], a[100:103], v[76:79], v[116:119]
s_waitcnt lgkmcnt(10)
v_add_f32 v232, v232, v236
v_mfma_f32_16x16x32_bf16 v[120:123], a[104:107], v[76:79], v[120:123]
v_add_f32 v233, v233, v237
v_add_f32 v234, v234, v238
v_mfma_f32_16x16x32_bf16 v[124:127], a[108:111], v[76:79], v[124:127]
v_add_f32 v235, v235, v239
v_add_f32 v240, v240, v244
v_mfma_f32_16x16x32_bf16 v[128:131], a[112:115], v[76:79], v[128:131]
v_add_f32 v241, v241, v245
v_add_f32 v242, v242, v246
v_mfma_f32_16x16x32_bf16 v[132:135], a[116:119], v[76:79], v[132:135]
v_add_f32 v243, v243, v247
s_waitcnt vmcnt(19)
v_mfma_f32_16x16x32_bf16 v[116:119], a[120:123], v[80:83], v[116:119]
buffer_load_dwordx4 v[76:79], v190, s[16:19], s46 offen offset:1024 sc1
v_mfma_f32_16x16x32_bf16 v[120:123], a[124:127], v[80:83], v[120:123]
v_add_f32 v232, v232, v240
v_add_f32 v233, v233, v241
v_mfma_f32_16x16x32_bf16 v[124:127], a[128:131], v[80:83], v[124:127]
v_add_f32 v234, v234, v242
v_add_f32 v235, v235, v243
v_mfma_f32_16x16x32_bf16 v[128:131], a[132:135], v[80:83], v[128:131]
v_mul_f32 v236, v248, v232
v_mul_f32 v237, v248, v233
v_mfma_f32_16x16x32_bf16 v[132:135], a[136:139], v[80:83], v[132:135]
buffer_load_dwordx4 v[80:83], v190, s[16:19], s47 offen offset:0 sc1
v_mfma_f32_16x16x32_bf16 v[116:119], a[140:143], v[84:87], v[116:119]
v_mul_f32 v238, v248, v234
v_mul_f32 v239, v248, v235
v_mfma_f32_16x16x32_bf16 v[120:123], a[144:147], v[84:87], v[120:123]
v_perm_b32 v236, v236, v186, s54
v_perm_b32 v237, v237, v186, s55
v_mfma_f32_16x16x32_bf16 v[124:127], a[148:151], v[84:87], v[124:127]
v_perm_b32 v238, v238, v186, s56
v_perm_b32 v239, v239, v186, s57
v_mfma_f32_16x16x32_bf16 v[128:131], a[152:155], v[84:87], v[128:131]
buffer_store_dwordx4 v[236:239], v179, s[16:19], s49 offen offset:2048 sc1
v_mfma_f32_16x16x32_bf16 v[132:135], a[156:159], v[84:87], v[132:135]
s_waitcnt vmcnt(20)
v_mfma_f32_16x16x32_bf16 v[116:119], a[160:163], v[88:91], v[116:119]
buffer_load_dwordx4 v[84:87], v190, s[16:19], s47 offen offset:1024 sc1
v_mfma_f32_16x16x32_bf16 v[120:123], a[164:167], v[88:91], v[120:123]
v_mfma_f32_16x16x32_bf16 v[124:127], a[168:171], v[88:91], v[124:127]
v_mfma_f32_16x16x32_bf16 v[128:131], a[172:175], v[88:91], v[128:131]
v_mfma_f32_16x16x32_bf16 v[132:135], a[176:179], v[88:91], v[132:135]
buffer_load_dwordx4 v[88:91], v190, s[16:19], s48 offen offset:0 sc1
v_mfma_f32_16x16x32_bf16 v[116:119], a[180:183], v[92:95], v[116:119]
v_mfma_f32_16x16x32_bf16 v[120:123], a[184:187], v[92:95], v[120:123]
v_mfma_f32_16x16x32_bf16 v[124:127], a[188:191], v[92:95], v[124:127]
v_mfma_f32_16x16x32_bf16 v[128:131], a[192:195], v[92:95], v[128:131]
v_mfma_f32_16x16x32_bf16 v[132:135], a[196:199], v[92:95], v[132:135]
s_waitcnt vmcnt(20)
v_mfma_f32_16x16x32_bf16 v[96:99], a[0:3], v[16:19], 0
buffer_load_dwordx4 v[92:95], v190, s[16:19], s48 offen offset:1024 sc1
v_mfma_f32_16x16x32_bf16 v[100:103], a[4:7], v[16:19], 0
v_add_u32 v190, s64, v199
v_mfma_f32_16x16x32_bf16 v[104:107], a[8:11], v[16:19], 0
v_mfma_f32_16x16x32_bf16 v[108:111], a[12:15], v[16:19], 0
ds_write_b64 v191, v[116:117] offset:46080
v_mfma_f32_16x16x32_bf16 v[112:115], a[16:19], v[16:19], 0
buffer_load_dwordx4 v[16:19], v190, s[16:19], s44 offen offset:0 sc1
v_mfma_f32_16x16x32_bf16 v[96:99], a[20:23], v[20:23], v[96:99]
ds_write_b64 v191, v[118:119] offset:46088
v_mfma_f32_16x16x32_bf16 v[100:103], a[24:27], v[20:23], v[100:103]
ds_write_b64 v191, v[120:121] offset:46144
v_mfma_f32_16x16x32_bf16 v[104:107], a[28:31], v[20:23], v[104:107]
ds_write_b64 v191, v[122:123] offset:46152
v_mfma_f32_16x16x32_bf16 v[108:111], a[32:35], v[20:23], v[108:111]
ds_write_b64 v191, v[124:125] offset:46208
v_mfma_f32_16x16x32_bf16 v[112:115], a[36:39], v[20:23], v[112:115]
ds_write_b64 v191, v[126:127] offset:46216
s_waitcnt vmcnt(20)
v_mfma_f32_16x16x32_bf16 v[96:99], a[40:43], v[24:27], v[96:99]
buffer_load_dwordx4 v[20:23], v190, s[16:19], s44 offen offset:1024 sc1
v_mfma_f32_16x16x32_bf16 v[100:103], a[44:47], v[24:27], v[100:103]
ds_write_b64 v191, v[128:129] offset:46272
v_mfma_f32_16x16x32_bf16 v[104:107], a[48:51], v[24:27], v[104:107]
ds_write_b64 v191, v[130:131] offset:46280
v_mfma_f32_16x16x32_bf16 v[108:111], a[52:55], v[24:27], v[108:111]
ds_write_b64 v191, v[132:133] offset:46336
v_mfma_f32_16x16x32_bf16 v[112:115], a[56:59], v[24:27], v[112:115]
buffer_load_dwordx4 v[24:27], v190, s[16:19], s45 offen offset:0 sc1
v_mfma_f32_16x16x32_bf16 v[96:99], a[60:63], v[28:31], v[96:99]
ds_write_b64 v191, v[134:135] offset:46344
v_mfma_f32_16x16x32_bf16 v[100:103], a[64:67], v[28:31], v[100:103]
v_mfma_f32_16x16x32_bf16 v[104:107], a[68:71], v[28:31], v[104:107]
v_mfma_f32_16x16x32_bf16 v[108:111], a[72:75], v[28:31], v[108:111]
v_mfma_f32_16x16x32_bf16 v[112:115], a[76:79], v[28:31], v[112:115]
s_waitcnt vmcnt(20)
v_mfma_f32_16x16x32_bf16 v[96:99], a[80:83], v[32:35], v[96:99]
buffer_load_dwordx4 v[28:31], v190, s[16:19], s45 offen offset:1024 sc1
v_mfma_f32_16x16x32_bf16 v[100:103], a[84:87], v[32:35], v[100:103]
s_waitcnt lgkmcnt(0)
s_barrier
v_mfma_f32_16x16x32_bf16 v[104:107], a[88:91], v[32:35], v[104:107]
ds_read_b128 v[232:235], v148 offset:0
v_mfma_f32_16x16x32_bf16 v[108:111], a[92:95], v[32:35], v[108:111]
ds_read_b128 v[236:239], v148 offset:10240
v_mfma_f32_16x16x32_bf16 v[112:115], a[96:99], v[32:35], v[112:115]
buffer_load_dwordx4 v[32:35], v190, s[16:19], s46 offen offset:0 sc1
v_mfma_f32_16x16x32_bf16 v[96:99], a[100:103], v[36:39], v[96:99]
ds_read_b128 v[240:243], v148 offset:20480
v_mfma_f32_16x16x32_bf16 v[100:103], a[104:107], v[36:39], v[100:103]
ds_read_b128 v[244:247], v148 offset:30720
v_mfma_f32_16x16x32_bf16 v[104:107], a[108:111], v[36:39], v[104:107]
ds_read_b128 v[156:159], v149 offset:0
v_mfma_f32_16x16x32_bf16 v[108:111], a[112:115], v[36:39], v[108:111]
ds_read_b128 v[160:163], v149 offset:10240
v_mfma_f32_16x16x32_bf16 v[112:115], a[116:119], v[36:39], v[112:115]
ds_read_b128 v[164:167], v149 offset:20480
s_waitcnt vmcnt(20)
v_mfma_f32_16x16x32_bf16 v[96:99], a[120:123], v[40:43], v[96:99]
buffer_load_dwordx4 v[36:39], v190, s[16:19], s46 offen offset:1024 sc1
v_mfma_f32_16x16x32_bf16 v[100:103], a[124:127], v[40:43], v[100:103]
ds_read_b128 v[168:171], v149 offset:30720
v_mfma_f32_16x16x32_bf16 v[104:107], a[128:131], v[40:43], v[104:107]
v_mfma_f32_16x16x32_bf16 v[108:111], a[132:135], v[40:43], v[108:111]
s_waitcnt lgkmcnt(4)
v_mfma_f32_16x16x32_bf16 v[112:115], a[136:139], v[40:43], v[112:115]
buffer_load_dwordx4 v[40:43], v190, s[16:19], s47 offen offset:0 sc1
v_mfma_f32_16x16x32_bf16 v[96:99], a[140:143], v[44:47], v[96:99]
v_pk_add_f32 v[232:233], v[232:233], v[236:237]
v_pk_add_f32 v[234:235], v[234:235], v[238:239]
v_pk_add_f32 v[240:241], v[240:241], v[244:245]
v_pk_add_f32 v[242:243], v[242:243], v[246:247]
v_pk_add_f32 v[232:233], v[232:233], v[240:241]
v_pk_add_f32 v[234:235], v[234:235], v[242:243]
v_mfma_f32_16x16x32_bf16 v[100:103], a[144:147], v[44:47], v[100:103]
v_mul_f32 v236, v249, v232
v_mul_f32 v237, v249, v233
v_mfma_f32_16x16x32_bf16 v[104:107], a[148:151], v[44:47], v[104:107]
v_mul_f32 v238, v249, v234
v_mul_f32 v239, v249, v235
v_mfma_f32_16x16x32_bf16 v[108:111], a[152:155], v[44:47], v[108:111]
v_perm_b32 v236, v236, v186, s54
v_perm_b32 v237, v237, v186, s55
v_mfma_f32_16x16x32_bf16 v[112:115], a[156:159], v[44:47], v[112:115]
v_perm_b32 v238, v238, v186, s56
s_waitcnt vmcnt(19)
v_mfma_f32_16x16x32_bf16 v[96:99], a[160:163], v[48:51], v[96:99]
buffer_load_dwordx4 v[44:47], v190, s[16:19], s47 offen offset:1024 sc1
v_mfma_f32_16x16x32_bf16 v[100:103], a[164:167], v[48:51], v[100:103]
v_perm_b32 v239, v239, v186, s57
v_mfma_f32_16x16x32_bf16 v[104:107], a[168:171], v[48:51], v[104:107]
buffer_store_dwordx4 v[236:239], v178, s[16:19], s50 offen offset:0 sc1
v_mfma_f32_16x16x32_bf16 v[108:111], a[172:175], v[48:51], v[108:111]
ds_read_b128 v[232:235], v150 offset:0
s_waitcnt lgkmcnt(1)
v_mfma_f32_16x16x32_bf16 v[112:115], a[176:179], v[48:51], v[112:115]
buffer_load_dwordx4 v[48:51], v190, s[16:19], s48 offen offset:0 sc1
v_mfma_f32_16x16x32_bf16 v[96:99], a[180:183], v[52:55], v[96:99]
ds_read_b128 v[236:239], v150 offset:10240
v_mfma_f32_16x16x32_bf16 v[100:103], a[184:187], v[52:55], v[100:103]
ds_read_b128 v[240:243], v150 offset:20480
v_mfma_f32_16x16x32_bf16 v[104:107], a[188:191], v[52:55], v[104:107]
ds_read_b128 v[244:247], v150 offset:30720
v_mfma_f32_16x16x32_bf16 v[108:111], a[192:195], v[52:55], v[108:111]
v_pk_add_f32 v[156:157], v[156:157], v[160:161]
v_pk_add_f32 v[158:159], v[158:159], v[162:163]
v_pk_add_f32 v[164:165], v[164:165], v[168:169]
v_pk_add_f32 v[166:167], v[166:167], v[170:171]
v_pk_add_f32 v[156:157], v[156:157], v[164:165]
v_pk_add_f32 v[158:159], v[158:159], v[166:167]
v_mfma_f32_16x16x32_bf16 v[112:115], a[196:199], v[52:55], v[112:115]
v_mul_f32 v160, v250, v156
s_waitcnt vmcnt(20)
v_mfma_f32_16x16x32_bf16 v[116:119], a[0:3], v[56:59], 0
buffer_load_dwordx4 v[52:55], v190, s[16:19], s48 offen offset:1024 sc1
v_mfma_f32_16x16x32_bf16 v[120:123], a[4:7], v[56:59], 0
v_add_u32 v190, s65, v199
v_mul_f32 v161, v250, v157
v_mfma_f32_16x16x32_bf16 v[124:127], a[8:11], v[56:59], 0
v_mul_f32 v162, v250, v158
v_mul_f32 v163, v250, v159
v_mfma_f32_16x16x32_bf16 v[128:131], a[12:15], v[56:59], 0
v_perm_b32 v160, v160, v186, s54
v_perm_b32 v161, v161, v186, s55
v_mfma_f32_16x16x32_bf16 v[132:135], a[16:19], v[56:59], 0
buffer_load_dwordx4 v[56:59], v190, s[16:19], s44 offen offset:0 sc1
v_mfma_f32_16x16x32_bf16 v[116:119], a[20:23], v[60:63], v[116:119]
v_perm_b32 v162, v162, v186, s56
v_perm_b32 v163, v163, v186, s57
v_mfma_f32_16x16x32_bf16 v[120:123], a[24:27], v[60:63], v[120:123]
buffer_store_dwordx4 v[160:163], v178, s[16:19], s50 offen offset:1024 sc1
v_mfma_f32_16x16x32_bf16 v[124:127], a[28:31], v[60:63], v[124:127]
s_waitcnt lgkmcnt(0)
ds_write_b64 v191, v[96:97] offset:0
v_mfma_f32_16x16x32_bf16 v[128:131], a[32:35], v[60:63], v[128:131]
v_pk_add_f32 v[232:233], v[232:233], v[236:237]
v_pk_add_f32 v[234:235], v[234:235], v[238:239]
v_pk_add_f32 v[240:241], v[240:241], v[244:245]
v_pk_add_f32 v[242:243], v[242:243], v[246:247]
v_pk_add_f32 v[232:233], v[232:233], v[240:241]
v_pk_add_f32 v[234:235], v[234:235], v[242:243]
v_mfma_f32_16x16x32_bf16 v[132:135], a[36:39], v[60:63], v[132:135]
v_mul_f32 v236, v251, v232
s_waitcnt vmcnt(21)
v_mfma_f32_16x16x32_bf16 v[116:119], a[40:43], v[64:67], v[116:119]
buffer_load_dwordx4 v[60:63], v190, s[16:19], s44 offen offset:1024 sc1
v_mfma_f32_16x16x32_bf16 v[120:123], a[44:47], v[64:67], v[120:123]
v_mul_f32 v237, v251, v233
v_mul_f32 v238, v251, v234
v_mfma_f32_16x16x32_bf16 v[124:127], a[48:51], v[64:67], v[124:127]
v_mul_f32 v239, v251, v235
v_perm_b32 v236, v236, v186, s54
v_mfma_f32_16x16x32_bf16 v[128:131], a[52:55], v[64:67], v[128:131]
v_perm_b32 v237, v237, v186, s55
v_perm_b32 v238, v238, v186, s56
v_mfma_f32_16x16x32_bf16 v[132:135], a[56:59], v[64:67], v[132:135]
buffer_load_dwordx4 v[64:67], v190, s[16:19], s45 offen offset:0 sc1
v_mfma_f32_16x16x32_bf16 v[116:119], a[60:63], v[68:71], v[116:119]
v_perm_b32 v239, v239, v186, s57
ds_write_b64 v191, v[98:99] offset:8
v_mfma_f32_16x16x32_bf16 v[120:123], a[64:67], v[68:71], v[120:123]
buffer_store_dwordx4 v[236:239], v179, s[16:19], s50 offen offset:2048 sc1
v_mfma_f32_16x16x32_bf16 v[124:127], a[68:71], v[68:71], v[124:127]
ds_write_b64 v191, v[100:101] offset:64
v_mfma_f32_16x16x32_bf16 v[128:131], a[72:75], v[68:71], v[128:131]
ds_write_b64 v191, v[102:103] offset:72
v_mfma_f32_16x16x32_bf16 v[132:135], a[76:79], v[68:71], v[132:135]
ds_write_b64 v191, v[104:105] offset:128
s_waitcnt vmcnt(21)
v_mfma_f32_16x16x32_bf16 v[116:119], a[80:83], v[72:75], v[116:119]
buffer_load_dwordx4 v[68:71], v190, s[16:19], s45 offen offset:1024 sc1
v_mfma_f32_16x16x32_bf16 v[120:123], a[84:87], v[72:75], v[120:123]
ds_write_b64 v191, v[106:107] offset:136
v_mfma_f32_16x16x32_bf16 v[124:127], a[88:91], v[72:75], v[124:127]
ds_write_b64 v191, v[108:109] offset:192
v_mfma_f32_16x16x32_bf16 v[128:131], a[92:95], v[72:75], v[128:131]
ds_write_b64 v191, v[110:111] offset:200
v_mfma_f32_16x16x32_bf16 v[132:135], a[96:99], v[72:75], v[132:135]
buffer_load_dwordx4 v[72:75], v190, s[16:19], s46 offen offset:0 sc1
v_mfma_f32_16x16x32_bf16 v[116:119], a[100:103], v[76:79], v[116:119]
ds_write_b64 v191, v[112:113] offset:256
v_mfma_f32_16x16x32_bf16 v[120:123], a[104:107], v[76:79], v[120:123]
ds_write_b64 v191, v[114:115] offset:264
v_mfma_f32_16x16x32_bf16 v[124:127], a[108:111], v[76:79], v[124:127]
v_mfma_f32_16x16x32_bf16 v[128:131], a[112:115], v[76:79], v[128:131]
v_mfma_f32_16x16x32_bf16 v[132:135], a[116:119], v[76:79], v[132:135]
s_waitcnt vmcnt(20)
v_mfma_f32_16x16x32_bf16 v[116:119], a[120:123], v[80:83], v[116:119]
buffer_load_dwordx4 v[76:79], v190, s[16:19], s46 offen offset:1024 sc1
v_mfma_f32_16x16x32_bf16 v[120:123], a[124:127], v[80:83], v[120:123]
v_mfma_f32_16x16x32_bf16 v[124:127], a[128:131], v[80:83], v[124:127]
v_mfma_f32_16x16x32_bf16 v[128:131], a[132:135], v[80:83], v[128:131]
v_mfma_f32_16x16x32_bf16 v[132:135], a[136:139], v[80:83], v[132:135]
buffer_load_dwordx4 v[80:83], v190, s[16:19], s47 offen offset:0 sc1
v_mfma_f32_16x16x32_bf16 v[116:119], a[140:143], v[84:87], v[116:119]
v_mfma_f32_16x16x32_bf16 v[120:123], a[144:147], v[84:87], v[120:123]
v_mfma_f32_16x16x32_bf16 v[124:127], a[148:151], v[84:87], v[124:127]
v_mfma_f32_16x16x32_bf16 v[128:131], a[152:155], v[84:87], v[128:131]
v_mfma_f32_16x16x32_bf16 v[132:135], a[156:159], v[84:87], v[132:135]
s_waitcnt vmcnt(20)
v_mfma_f32_16x16x32_bf16 v[116:119], a[160:163], v[88:91], v[116:119]
buffer_load_dwordx4 v[84:87], v190, s[16:19], s47 offen offset:1024 sc1
v_mfma_f32_16x16x32_bf16 v[120:123], a[164:167], v[88:91], v[120:123]
v_mfma_f32_16x16x32_bf16 v[124:127], a[168:171], v[88:91], v[124:127]
v_mfma_f32_16x16x32_bf16 v[128:131], a[172:175], v[88:91], v[128:131]
v_mfma_f32_16x16x32_bf16 v[132:135], a[176:179], v[88:91], v[132:135]
buffer_load_dwordx4 v[88:91], v190, s[16:19], s48 offen offset:0 sc1
v_mfma_f32_16x16x32_bf16 v[116:119], a[180:183], v[92:95], v[116:119]
v_mfma_f32_16x16x32_bf16 v[120:123], a[184:187], v[92:95], v[120:123]
v_mfma_f32_16x16x32_bf16 v[124:127], a[188:191], v[92:95], v[124:127]
v_mfma_f32_16x16x32_bf16 v[128:131], a[192:195], v[92:95], v[128:131]
v_mfma_f32_16x16x32_bf16 v[132:135], a[196:199], v[92:95], v[132:135]
s_waitcnt vmcnt(20)
v_mfma_f32_16x16x32_bf16 v[96:99], a[0:3], v[16:19], 0
buffer_load_dwordx4 v[92:95], v190, s[16:19], s48 offen offset:1024 sc1
v_mfma_f32_16x16x32_bf16 v[100:103], a[4:7], v[16:19], 0
v_mfma_f32_16x16x32_bf16 v[104:107], a[8:11], v[16:19], 0
v_mfma_f32_16x16x32_bf16 v[108:111], a[12:15], v[16:19], 0
ds_write_b64 v191, v[116:117] offset:5120
v_mfma_f32_16x16x32_bf16 v[112:115], a[16:19], v[16:19], 0
v_mfma_f32_16x16x32_bf16 v[96:99], a[20:23], v[20:23], v[96:99]
ds_write_b64 v191, v[118:119] offset:5128
v_mfma_f32_16x16x32_bf16 v[100:103], a[24:27], v[20:23], v[100:103]
v_mfma_f32_16x16x32_bf16 v[104:107], a[28:31], v[20:23], v[104:107]
ds_write_b64 v191, v[120:121] offset:5184
v_mfma_f32_16x16x32_bf16 v[108:111], a[32:35], v[20:23], v[108:111]
v_mfma_f32_16x16x32_bf16 v[112:115], a[36:39], v[20:23], v[112:115]
ds_write_b64 v191, v[122:123] offset:5192
s_waitcnt vmcnt(19)
v_mfma_f32_16x16x32_bf16 v[96:99], a[40:43], v[24:27], v[96:99]
v_mfma_f32_16x16x32_bf16 v[100:103], a[44:47], v[24:27], v[100:103]
ds_write_b64 v191, v[124:125] offset:5248
v_mfma_f32_16x16x32_bf16 v[104:107], a[48:51], v[24:27], v[104:107]
v_mfma_f32_16x16x32_bf16 v[108:111], a[52:55], v[24:27], v[108:111]
ds_write_b64 v191, v[126:127] offset:5256
v_mfma_f32_16x16x32_bf16 v[112:115], a[56:59], v[24:27], v[112:115]
v_mfma_f32_16x16x32_bf16 v[96:99], a[60:63], v[28:31], v[96:99]
ds_write_b64 v191, v[128:129] offset:5312
v_mfma_f32_16x16x32_bf16 v[100:103], a[64:67], v[28:31], v[100:103]
v_mfma_f32_16x16x32_bf16 v[104:107], a[68:71], v[28:31], v[104:107]
ds_write_b64 v191, v[130:131] offset:5320
v_mfma_f32_16x16x32_bf16 v[108:111], a[72:75], v[28:31], v[108:111]
v_mfma_f32_16x16x32_bf16 v[112:115], a[76:79], v[28:31], v[112:115]
ds_write_b64 v191, v[132:133] offset:5376
s_waitcnt vmcnt(17)
v_mfma_f32_16x16x32_bf16 v[96:99], a[80:83], v[32:35], v[96:99]
v_mfma_f32_16x16x32_bf16 v[100:103], a[84:87], v[32:35], v[100:103]
ds_write_b64 v191, v[134:135] offset:5384
v_mfma_f32_16x16x32_bf16 v[104:107], a[88:91], v[32:35], v[104:107]
v_mfma_f32_16x16x32_bf16 v[108:111], a[92:95], v[32:35], v[108:111]
v_mfma_f32_16x16x32_bf16 v[112:115], a[96:99], v[32:35], v[112:115]
v_mfma_f32_16x16x32_bf16 v[96:99], a[100:103], v[36:39], v[96:99]
v_mfma_f32_16x16x32_bf16 v[100:103], a[104:107], v[36:39], v[100:103]
v_mfma_f32_16x16x32_bf16 v[104:107], a[108:111], v[36:39], v[104:107]
s_waitcnt lgkmcnt(0)
s_barrier
v_mfma_f32_16x16x32_bf16 v[108:111], a[112:115], v[36:39], v[108:111]
ds_read_b128 v[232:235], v192 offset:0
v_mfma_f32_16x16x32_bf16 v[112:115], a[116:119], v[36:39], v[112:115]
ds_read_b128 v[236:239], v192 offset:10240
s_waitcnt vmcnt(15)
v_mfma_f32_16x16x32_bf16 v[96:99], a[120:123], v[40:43], v[96:99]
ds_read_b128 v[240:243], v192 offset:20480
v_mfma_f32_16x16x32_bf16 v[100:103], a[124:127], v[40:43], v[100:103]
ds_read_b128 v[244:247], v192 offset:30720
v_mfma_f32_16x16x32_bf16 v[104:107], a[128:131], v[40:43], v[104:107]
ds_read_b128 v[156:159], v193 offset:0
v_mfma_f32_16x16x32_bf16 v[108:111], a[132:135], v[40:43], v[108:111]
ds_read_b128 v[160:163], v193 offset:10240
v_mfma_f32_16x16x32_bf16 v[112:115], a[136:139], v[40:43], v[112:115]
ds_read_b128 v[164:167], v193 offset:20480
v_mfma_f32_16x16x32_bf16 v[96:99], a[140:143], v[44:47], v[96:99]
ds_read_b128 v[168:171], v193 offset:30720
v_mfma_f32_16x16x32_bf16 v[100:103], a[144:147], v[44:47], v[100:103]
v_mfma_f32_16x16x32_bf16 v[104:107], a[148:151], v[44:47], v[104:107]
s_waitcnt lgkmcnt(4)
v_add_f32 v232, v232, v236
v_mfma_f32_16x16x32_bf16 v[108:111], a[152:155], v[44:47], v[108:111]
v_add_f32 v233, v233, v237
v_add_f32 v234, v234, v238
v_mfma_f32_16x16x32_bf16 v[112:115], a[156:159], v[44:47], v[112:115]
v_add_f32 v235, v235, v239
s_waitcnt vmcnt(12)
v_mfma_f32_16x16x32_bf16 v[96:99], a[160:163], v[48:51], v[96:99]
v_add_f32 v240, v240, v244
v_add_f32 v241, v241, v245
v_mfma_f32_16x16x32_bf16 v[100:103], a[164:167], v[48:51], v[100:103]
v_add_f32 v242, v242, v246
v_add_f32 v243, v243, v247
v_mfma_f32_16x16x32_bf16 v[104:107], a[168:171], v[48:51], v[104:107]
v_add_f32 v232, v232, v240
v_add_f32 v233, v233, v241
v_mfma_f32_16x16x32_bf16 v[108:111], a[172:175], v[48:51], v[108:111]
v_add_f32 v234, v234, v242
v_add_f32 v235, v235, v243
v_mfma_f32_16x16x32_bf16 v[112:115], a[176:179], v[48:51], v[112:115]
v_fmac_f32 v200, v136, v232
v_fmac_f32 v201, v136, v233
v_mfma_f32_16x16x32_bf16 v[96:99], a[180:183], v[52:55], v[96:99]
buffer_load_dwordx4 v[2:5], v178, s[16:19], s51 offen offset:0 sc1
v_mfma_f32_16x16x32_bf16 v[100:103], a[184:187], v[52:55], v[100:103]
buffer_load_dwordx4 v[6:9], v178, s[16:19], s51 offen offset:1024 sc1
v_mfma_f32_16x16x32_bf16 v[104:107], a[188:191], v[52:55], v[104:107]
buffer_load_dwordx4 v[10:13], v152, s[16:19], s51 offen offset:2048 sc1
v_mfma_f32_16x16x32_bf16 v[108:111], a[192:195], v[52:55], v[108:111]
buffer_load_dwordx4 v[16:19], v178, s[16:19], s52 offen offset:0 sc1
v_mfma_f32_16x16x32_bf16 v[112:115], a[196:199], v[52:55], v[112:115]
v_fmac_f32 v202, v136, v234
s_waitcnt vmcnt(13)
v_mfma_f32_16x16x32_bf16 v[116:119], a[0:3], v[56:59], 0
buffer_load_dwordx4 v[20:23], v178, s[16:19], s52 offen offset:1024 sc1
v_mfma_f32_16x16x32_bf16 v[120:123], a[4:7], v[56:59], 0
buffer_load_dwordx4 v[24:27], v152, s[16:19], s52 offen offset:2048 sc1
v_mfma_f32_16x16x32_bf16 v[124:127], a[8:11], v[56:59], 0
v_fmac_f32 v203, v136, v235
s_waitcnt lgkmcnt(0)
v_mfma_f32_16x16x32_bf16 v[128:131], a[12:15], v[56:59], 0
ds_write_b64 v191, v[96:97] offset:40960
ds_read_b128 v[232:235], v189 offset:0
v_mfma_f32_16x16x32_bf16 v[132:135], a[16:19], v[56:59], 0
ds_read_b128 v[236:239], v189 offset:10240
v_add_f32 v156, v156, v160
v_mfma_f32_16x16x32_bf16 v[116:119], a[20:23], v[60:63], v[116:119]
ds_write_b64 v191, v[98:99] offset:40968
ds_read_b128 v[240:243], v189 offset:20480
v_mfma_f32_16x16x32_bf16 v[120:123], a[24:27], v[60:63], v[120:123]
ds_read_b128 v[244:247], v189 offset:30720
v_add_f32 v157, v157, v161
v_mfma_f32_16x16x32_bf16 v[124:127], a[28:31], v[60:63], v[124:127]
ds_write_b64 v191, v[100:101] offset:41024
v_add_f32 v158, v158, v162
v_mfma_f32_16x16x32_bf16 v[128:131], a[32:35], v[60:63], v[128:131]
v_add_f32 v159, v159, v163
v_add_f32 v164, v164, v168
v_mfma_f32_16x16x32_bf16 v[132:135], a[36:39], v[60:63], v[132:135]
ds_write_b64 v191, v[102:103] offset:41032
s_waitcnt vmcnt(12)
v_mfma_f32_16x16x32_bf16 v[116:119], a[40:43], v[64:67], v[116:119]
v_add_f32 v165, v165, v169
v_add_f32 v166, v166, v170
v_mfma_f32_16x16x32_bf16 v[120:123], a[44:47], v[64:67], v[120:123]
ds_write_b64 v191, v[104:105] offset:41088
v_add_f32 v167, v167, v171
v_mfma_f32_16x16x32_bf16 v[124:127], a[48:51], v[64:67], v[124:127]
v_add_f32 v156, v156, v164
v_add_f32 v157, v157, v165
v_mfma_f32_16x16x32_bf16 v[128:131], a[52:55], v[64:67], v[128:131]
ds_write_b64 v191, v[106:107] offset:41096
v_add_f32 v158, v158, v166
v_mfma_f32_16x16x32_bf16 v[132:135], a[56:59], v[64:67], v[132:135]
v_add_f32 v159, v159, v167
v_fmac_f32 v204, v138, v156
v_mfma_f32_16x16x32_bf16 v[116:119], a[60:63], v[68:71], v[116:119]
ds_write_b64 v191, v[108:109] offset:41152
v_fmac_f32 v205, v138, v157
v_mfma_f32_16x16x32_bf16 v[120:123], a[64:67], v[68:71], v[120:123]
v_fmac_f32 v206, v138, v158
v_fmac_f32 v207, v138, v159
v_mfma_f32_16x16x32_bf16 v[124:127], a[68:71], v[68:71], v[124:127]
ds_write_b64 v191, v[110:111] offset:41160
s_waitcnt lgkmcnt(6)
v_mfma_f32_16x16x32_bf16 v[128:131], a[72:75], v[68:71], v[128:131]
v_add_f32 v232, v232, v236
v_add_f32 v233, v233, v237
v_mfma_f32_16x16x32_bf16 v[132:135], a[76:79], v[68:71], v[132:135]
ds_write_b64 v191, v[112:113] offset:41216
s_waitcnt vmcnt(10)
v_mfma_f32_16x16x32_bf16 v[116:119], a[80:83], v[72:75], v[116:119]
v_add_f32 v234, v234, v238
v_add_f32 v235, v235, v239
v_mfma_f32_16x16x32_bf16 v[120:123], a[84:87], v[72:75], v[120:123]
ds_write_b64 v191, v[114:115] offset:41224
v_add_f32 v240, v240, v244
v_mfma_f32_16x16x32_bf16 v[124:127], a[88:91], v[72:75], v[124:127]
v_add_f32 v241, v241, v245
v_add_f32 v242, v242, v246
v_mfma_f32_16x16x32_bf16 v[128:131], a[92:95], v[72:75], v[128:131]
v_add_f32 v243, v243, v247
v_add_f32 v232, v232, v240
v_mfma_f32_16x16x32_bf16 v[132:135], a[96:99], v[72:75], v[132:135]
v_add_f32 v233, v233, v241
v_add_f32 v234, v234, v242
v_mfma_f32_16x16x32_bf16 v[116:119], a[100:103], v[76:79], v[116:119]
v_add_f32 v235, v235, v243
v_fmac_f32 v208, v140, v232
v_mfma_f32_16x16x32_bf16 v[120:123], a[104:107], v[76:79], v[120:123]
v_fmac_f32 v209, v140, v233
v_fmac_f32 v210, v140, v234
v_mfma_f32_16x16x32_bf16 v[124:127], a[108:111], v[76:79], v[124:127]
v_fmac_f32 v211, v140, v235
v_mfma_f32_16x16x32_bf16 v[128:131], a[112:115], v[76:79], v[128:131]
v_mfma_f32_16x16x32_bf16 v[132:135], a[116:119], v[76:79], v[132:135]
s_waitcnt vmcnt(8)
v_mfma_f32_16x16x32_bf16 v[116:119], a[120:123], v[80:83], v[116:119]
v_mfma_f32_16x16x32_bf16 v[120:123], a[124:127], v[80:83], v[120:123]
v_mfma_f32_16x16x32_bf16 v[124:127], a[128:131], v[80:83], v[124:127]
v_mfma_f32_16x16x32_bf16 v[128:131], a[132:135], v[80:83], v[128:131]
v_mfma_f32_16x16x32_bf16 v[132:135], a[136:139], v[80:83], v[132:135]
v_mfma_f32_16x16x32_bf16 v[116:119], a[140:143], v[84:87], v[116:119]
v_mfma_f32_16x16x32_bf16 v[120:123], a[144:147], v[84:87], v[120:123]
v_mfma_f32_16x16x32_bf16 v[124:127], a[148:151], v[84:87], v[124:127]
v_mfma_f32_16x16x32_bf16 v[128:131], a[152:155], v[84:87], v[128:131]
v_mfma_f32_16x16x32_bf16 v[132:135], a[156:159], v[84:87], v[132:135]
s_waitcnt vmcnt(6)
v_mfma_f32_16x16x32_bf16 v[116:119], a[160:163], v[88:91], v[116:119]
v_mfma_f32_16x16x32_bf16 v[120:123], a[164:167], v[88:91], v[120:123]
v_mfma_f32_16x16x32_bf16 v[124:127], a[168:171], v[88:91], v[124:127]
v_mfma_f32_16x16x32_bf16 v[128:131], a[172:175], v[88:91], v[128:131]
v_mfma_f32_16x16x32_bf16 v[132:135], a[176:179], v[88:91], v[132:135]
v_mfma_f32_16x16x32_bf16 v[116:119], a[180:183], v[92:95], v[116:119]
v_mfma_f32_16x16x32_bf16 v[120:123], a[184:187], v[92:95], v[120:123]
v_mfma_f32_16x16x32_bf16 v[124:127], a[188:191], v[92:95], v[124:127]
v_mfma_f32_16x16x32_bf16 v[128:131], a[192:195], v[92:95], v[128:131]
v_mfma_f32_16x16x32_bf16 v[132:135], a[196:199], v[92:95], v[132:135]
s_nop 3
ds_write_b128 v191, v[116:119] offset:46080
ds_write_b128 v191, v[120:123] offset:46144
ds_write_b128 v191, v[124:127] offset:46208
ds_write_b128 v191, v[128:131] offset:46272
s_nop 3
ds_write_b128 v191, v[132:135] offset:46336
s_waitcnt vmcnt(0)
v_perm_b32 v14, v3, v2, s68
v_perm_b32 v15, v5, v4, s69
v_bitop3_b32 v172, v14, v15, v186 bitop3:0x56
v_perm_b32 v14, v7, v6, s68
v_perm_b32 v15, v9, v8, s69
v_bitop3_b32 v173, v14, v15, v186 bitop3:0x56
v_perm_b32 v14, v11, v10, s68
v_perm_b32 v15, v13, v12, s69
v_bitop3_b32 v174, v14, v15, v186 bitop3:0x56
v_perm_b32 v14, v17, v16, s68
v_perm_b32 v15, v19, v18, s69
v_bitop3_b32 v175, v14, v15, v186 bitop3:0x56
v_perm_b32 v14, v21, v20, s68
v_perm_b32 v15, v23, v22, s69
v_bitop3_b32 v176, v14, v15, v186 bitop3:0x56
v_perm_b32 v14, v25, v24, s68
v_perm_b32 v15, v27, v26, s69
v_bitop3_b32 v177, v14, v15, v186 bitop3:0x56
v_or3_b32 v15, v172, v173, v174
v_or3_b32 v14, v175, v176, v177
v_or_b32 v15, v14, v15
v_cmp_ne_u32 vcc, 0, v15
s_nop 0
s_cbranch_vccnz L_x_slow
L_x_ok:
v_pk_add_f32 v[200:201], v[200:201], v[2:3]
v_pk_add_f32 v[202:203], v[202:203], v[4:5]
buffer_store_dwordx4 v[200:203], v194, s[28:31], s66 offen sc1
v_pk_add_f32 v[204:205], v[204:205], v[6:7]
v_pk_add_f32 v[206:207], v[206:207], v[8:9]
buffer_store_dwordx4 v[204:207], v195, s[28:31], s66 offen sc1
v_pk_add_f32 v[208:209], v[208:209], v[10:11]
v_pk_add_f32 v[210:211], v[210:211], v[12:13]
buffer_store_dwordx4 v[208:211], v188, s[28:31], s66 offen sc1
s_waitcnt lgkmcnt(0)
s_barrier
ds_read_b128 v[232:235], v148 offset:0
ds_read_b128 v[236:239], v148 offset:10240
ds_read_b128 v[240:243], v148 offset:20480
ds_read_b128 v[244:247], v148 offset:30720
ds_read_b128 v[156:159], v149 offset:0
ds_read_b128 v[160:163], v149 offset:10240
ds_read_b128 v[164:167], v149 offset:20480
ds_read_b128 v[168:171], v149 offset:30720
ds_read_b128 v[32:35], v150 offset:0
ds_read_b128 v[36:39], v150 offset:10240
ds_read_b128 v[40:43], v150 offset:20480
ds_read_b128 v[44:47], v150 offset:30720
v_pk_add_f32 v[212:213], v[212:213], v[16:17]
v_pk_add_f32 v[214:215], v[214:215], v[18:19]
s_waitcnt lgkmcnt(8)
v_pk_add_f32 v[232:233], v[232:233], v[236:237]
v_pk_add_f32 v[240:241], v[240:241], v[244:245]
v_pk_add_f32 v[234:235], v[234:235], v[238:239]
v_pk_add_f32 v[242:243], v[242:243], v[246:247]
v_pk_add_f32 v[232:233], v[232:233], v[240:241]
v_pk_add_f32 v[234:235], v[234:235], v[242:243]
v_pk_fma_f32 v[212:213], v[142:143], v[232:233], v[212:213] op_sel_hi:[0,1,1]
v_pk_fma_f32 v[214:215], v[142:143], v[234:235], v[214:215] op_sel_hi:[0,1,1]
buffer_store_dwordx4 v[212:215], v194, s[28:31], s67 offen sc1
v_pk_add_f32 v[216:217], v[216:217], v[20:21]
v_pk_add_f32 v[218:219], v[218:219], v[22:23]
s_waitcnt lgkmcnt(4)
v_pk_add_f32 v[156:157], v[156:157], v[160:161]
v_pk_add_f32 v[164:165], v[164:165], v[168:169]
v_pk_add_f32 v[158:159], v[158:159], v[162:163]
v_pk_add_f32 v[166:167], v[166:167], v[170:171]
v_pk_add_f32 v[156:157], v[156:157], v[164:165]
v_pk_add_f32 v[158:159], v[158:159], v[166:167]
v_pk_fma_f32 v[216:217], v[144:145], v[156:157], v[216:217] op_sel_hi:[0,1,1]
v_pk_fma_f32 v[218:219], v[144:145], v[158:159], v[218:219] op_sel_hi:[0,1,1]
buffer_store_dwordx4 v[216:219], v195, s[28:31], s67 offen sc1
v_pk_add_f32 v[220:221], v[220:221], v[24:25]
v_pk_add_f32 v[222:223], v[222:223], v[26:27]
s_waitcnt lgkmcnt(0)
v_pk_add_f32 v[32:33], v[32:33], v[36:37]
v_pk_add_f32 v[40:41], v[40:41], v[44:45]
v_pk_add_f32 v[34:35], v[34:35], v[38:39]
v_pk_add_f32 v[42:43], v[42:43], v[46:47]
v_pk_add_f32 v[32:33], v[32:33], v[40:41]
v_pk_add_f32 v[34:35], v[34:35], v[42:43]
v_pk_fma_f32 v[220:221], v[146:147], v[32:33], v[220:221] op_sel_hi:[0,1,1]
v_pk_fma_f32 v[222:223], v[146:147], v[34:35], v[222:223] op_sel_hi:[0,1,1]
buffer_store_dwordx4 v[220:223], v188, s[28:31], s67 offen sc1
L_end:
s_endpgm
L_tag_slow:
s_add_u32 s100, s100, 1
s_cmp_gt_u32 s100, 65536
s_cbranch_scc1 L_tag_ok
s_sleep 2
buffer_load_dwordx2 v[14:15], off, s[24:27], 0 sc1
s_waitcnt vmcnt(0)
s_branch L_tag
L_clr_slow:
s_cmp_gt_u32 s100, 65536
s_cbranch_scc1 L_clr_ok
s_sleep 2
buffer_load_dwordx2 v[6:7], v11, s[16:19], 0 offen sc1
s_waitcnt vmcnt(0)
s_branch L_clr
L_ep_slow:
s_cmp_gt_u32 s100, 65536
s_cbranch_scc1 L_ep_ok
buffer_load_dwordx2 v[96:97], v14, s[20:23], 0 offen offset:0 sc1
buffer_load_dwordx2 v[98:99], v14, s[20:23], 0 offen offset:640 sc1
buffer_load_dwordx2 v[100:101], v14, s[20:23], 0 offen offset:1280 sc1
buffer_load_dwordx2 v[102:103], v14, s[20:23], 0 offen offset:1920 sc1
buffer_load_dwordx2 v[104:105], v14, s[20:23], 0 offen offset:2560 sc1
buffer_load_dwordx2 v[106:107], v14, s[20:23], 0 offen offset:3200 sc1
buffer_load_dwordx2 v[108:109], v14, s[20:23], s56 offen offset:0 sc1
buffer_load_dwordx2 v[110:111], v14, s[20:23], s56 offen offset:640 sc1
buffer_load_dwordx2 v[112:113], v14, s[20:23], s56 offen offset:1280 sc1
buffer_load_dwordx2 v[114:115], v14, s[20:23], s56 offen offset:1920 sc1
buffer_load_dwordx2 v[116:117], v14, s[20:23], s56 offen offset:2560 sc1
buffer_load_dwordx2 v[118:119], v14, s[20:23], s56 offen offset:3200 sc1
buffer_load_dwordx2 v[120:121], v14, s[20:23], s57 offen offset:0 sc1
buffer_load_dwordx2 v[122:123], v14, s[20:23], s57 offen offset:640 sc1
buffer_load_dwordx2 v[124:125], v14, s[20:23], s57 offen offset:1280 sc1
s_waitcnt vmcnt(0)
s_branch L_ep_chk
L_g_slow:
s_cmp_gt_u32 s100, 65536
s_cbranch_scc1 L_g_ok
s_sleep 2
buffer_load_dwordx4 v[160:163], v177, s[16:19], 0 offen sc1
s_waitcnt vmcnt(0)
s_branch L_g
L_x_slow:
s_add_u32 s100, s100, 1
s_cmp_gt_u32 s100, 65536
s_cbranch_scc1 L_x_ok
buffer_load_dwordx4 v[2:5], v178, s[16:19], s51 offen offset:0 sc1
buffer_load_dwordx4 v[6:9], v178, s[16:19], s51 offen offset:1024 sc1
buffer_load_dwordx4 v[10:13], v152, s[16:19], s51 offen offset:2048 sc1
buffer_load_dwordx4 v[16:19], v178, s[16:19], s52 offen offset:0 sc1
buffer_load_dwordx4 v[20:23], v178, s[16:19], s52 offen offset:1024 sc1
buffer_load_dwordx4 v[24:27], v152, s[16:19], s52 offen offset:2048 sc1
s_waitcnt vmcnt(0)
v_perm_b32 v14, v3, v2, s68
v_perm_b32 v15, v5, v4, s69
v_bitop3_b32 v172, v14, v15, v186 bitop3:0x56
v_perm_b32 v14, v7, v6, s68
v_perm_b32 v15, v9, v8, s69
v_bitop3_b32 v173, v14, v15, v186 bitop3:0x56
v_perm_b32 v14, v11, v10, s68
v_perm_b32 v15, v13, v12, s69
v_bitop3_b32 v174, v14, v15, v186 bitop3:0x56
v_perm_b32 v14, v17, v16, s68
v_perm_b32 v15, v19, v18, s69
v_bitop3_b32 v175, v14, v15, v186 bitop3:0x56
v_perm_b32 v14, v21, v20, s68
v_perm_b32 v15, v23, v22, s69
v_bitop3_b32 v176, v14, v15, v186 bitop3:0x56
v_perm_b32 v14, v25, v24, s68
v_perm_b32 v15, v27, v26, s69
v_bitop3_b32 v177, v14, v15, v186 bitop3:0x56
v_or3_b32 v15, v172, v173, v174
v_or3_b32 v14, v175, v176, v177
v_or_b32 v15, v14, v15
v_cmp_ne_u32 vcc, 0, v15
s_nop 0
s_cbranch_vccnz L_x_slow
s_branch L_x_ok
L_last:
s_endpgm
.section .rodata,"a"
.p2align 6
.amdhsa_kernel gated_mix__ssm_conv_s5__ssm_conv_s5__prompt_kernel
  .amdhsa_next_free_vgpr 512
  .amdhsa_next_free_sgpr 102
  .amdhsa_accum_offset 256
  .amdhsa_group_segment_fixed_size 0
  .amdhsa_kernarg_size 176
  .amdhsa_user_sgpr_count 2
  .amdhsa_user_sgpr_kernarg_segment_ptr 1
  .amdhsa_system_sgpr_workgroup_id_x 1
  .amdhsa_float_denorm_mode_32 3
.end_amdhsa_kernel
```
